```python
import torch

def _softmax(x, axis=-1):
    return torch.softmax(x, dim=axis)
def _gelu(x):
    return torch.nn.functional.gelu(x, approximate="tanh")
def _silu(x):
    return torch.nn.functional.silu(x)
def _sigmoid(x):
    return torch.sigmoid(x)
def _layernorm(x, axis=-1, eps=1e-5):
    m = x.mean(dim=axis, keepdim=True)
    v = x.var(dim=axis, keepdim=True, unbiased=False)
    return (x - m) / torch.sqrt(v + eps)
def _scatter_add(tgt, idx, src, axis=0):
    return tgt.clone().index_add_(axis, idx, src)
def _segment_sum(src, seg, n):
    out = torch.zeros((n,) + src.shape[1:], dtype=src.dtype)
    return out.index_add_(0, seg, src)
def _pad(x, pw):
    flat = tuple(v for pair in reversed(pw) for v in pair)
    return torch.nn.functional.pad(x, flat)

kernel_name = 'recurrent_scan__ssm_conv_s4__dense_activation_mish__prompt'

def setup_inputs():

    _w = (lambda a: (lambda t: t.to(torch.bfloat16) if t.is_floating_point() else t)(torch.as_tensor(a)))
    def _A_setup():
        B, L, D, N = 1, 2048, 448, 256
        A_re = -(lambda _x: torch.exp(torch.as_tensor(_x)))((lambda *s: torch.randn(*s, dtype=torch.bfloat16) * 3.2)(D, N))
        A_im = torch.pi * (lambda *s: torch.randn(*s, dtype=torch.bfloat16) * 0.2)(D, N)
        B_re = (lambda *s: torch.randn(*s, dtype=torch.bfloat16) * 0.2)(D, N)
        B_im = (lambda *s: torch.randn(*s, dtype=torch.bfloat16) * 0.2)(D, N)
        C_re = (lambda *s: torch.randn(*s, dtype=torch.bfloat16) * 0.2)(D, N)
        C_im = (lambda *s: torch.randn(*s, dtype=torch.bfloat16) * 0.2)(D, N)
        log_dt = (lambda *s: torch.randn(*s, dtype=torch.bfloat16) * 0.2)(D) * 0.5 - 4.0
        Dskip = (lambda *s: torch.randn(*s, dtype=torch.bfloat16) * 0.2)(D)
        return {
            "u": _w((lambda *s: torch.randn(*s, dtype=torch.bfloat16) * 0.05)(B, L, D)),
            "A_re": _w(A_re),
            "A_im": _w(A_im),
            "B_re": _w(B_re),
            "B_im": _w(B_im),
            "C_re": _w(C_re),
            "C_im": _w(C_im),
            "log_dt": _w(log_dt),
            "Dskip": _w(Dskip),
        }
    _A_in = _A_setup()

    def _B_setup():
        B, S, D, F = 1, 2048, 448, 1792
        return {
            "x": _w((lambda *s: torch.randn(*s, dtype=torch.bfloat16) * 0.05)(B, S, D)),
            "w1": _w((lambda *s: torch.randn(*s, dtype=torch.bfloat16) * 0.8)(D, F) * (D ** -0.5)),
            "b1": _w((lambda *s: torch.randn(*s, dtype=torch.bfloat16) * 0.1)(F)),
            "w2": _w((lambda *s: torch.randn(*s, dtype=torch.bfloat16) * 0.1)(F, D) * (F ** -0.5)),
        }
    _B_in = _B_setup()

    return {
        "A_u": _A_in["u"],
        "A_A_re": _A_in["A_re"],
        "A_A_im": _A_in["A_im"],
        "A_B_re": _A_in["B_re"],
        "A_B_im": _A_in["B_im"],
        "A_C_re": _A_in["C_re"],
        "A_C_im": _A_in["C_im"],
        "A_log_dt": _A_in["log_dt"],
        "A_Dskip": _A_in["Dskip"],
        "B_x": _B_in["x"],
        "B_w1": _B_in["w1"],
        "B_b1": _B_in["b1"],
        "B_w2": _B_in["w2"],
    }

def reference(A_u, A_A_re, A_A_im, A_B_re, A_B_im, A_C_re, A_C_im, A_log_dt, A_Dskip, B_x, B_w1, B_b1, B_w2):
    def _A_ref(u, A_re, A_im, B_re, B_im, C_re, C_im, log_dt, Dskip):
        Bsz, L, D = u.shape
        dt = torch.exp(log_dt)[:, None]
        A = A_re + 1j * A_im
        Bc = B_re + 1j * B_im
        Cc = C_re + 1j * C_im
        logdA = dt * A
        dB = dt * Bc
        l = (lambda x, dt: x.to(dt))(torch.arange(L), A_re.dtype)
        P = torch.exp(logdA[:, :, None] * l[None, None, :])
        K = torch.einsum("dn,dnl,dn->dl", Cc, P, dB).real
        L2 = 2 * L
        Kp = _pad(K, ((0, 0), (0, L)))
        up = (lambda x, *d: x.permute(*d))(u, 0, 2, 1)
        up = _pad(up, ((0, 0), (0, 0), (0, L)))
        Kf = (lambda x, axes=(-2,-1): torch.fft.rfft2(x.float(), dim=axes))(Kp[:, None, :], axes=(-2, -1))
        Uf = (lambda x, axes=(-2,-1): torch.fft.rfft2(x.float(), dim=axes))(up[:, :, None, :], axes=(-2, -1))
        Yf = Uf * Kf[None, :, :, :]
        y = (lambda x, s, axes=(-2,-1): torch.fft.irfft2(x, s=s, dim=axes).to(torch.bfloat16))(Yf, (1, L2), axes=(-2, -1))[:, :, 0, :L]
        y = (lambda x, *d: x.permute(*d))(y, 0, 2, 1) + u * Dskip[None, None, :]
        return y

    def _B_ref(x, w1, b1, w2):
        h = torch.einsum("bsd,df->bsf", x, w1) + b1
        sp = torch.log1p(torch.exp(-torch.abs(h))) + torch.where(h > 0, h, torch.zeros_like(h))
        act = h * torch.tanh(sp)
        return torch.einsum("bsf,fd->bsd", act, w2)

    x = A_u
    xn = _layernorm(x, axis=-1)
    s = _A_ref(xn, A_A_re, A_A_im, A_B_re, A_B_im, A_C_re, A_C_im, A_log_dt, A_Dskip)
    g = _silu(_B_ref(xn, B_w1, B_b1, B_w2))
    return x + s * g
```

```asm
; @launch grid=(256,1,1) block=(512,1,1) lds=163840
.amdgcn_target "amdgcn-amd-amdhsa--gfx950"
.text
.p2align 12
.fill 832, 4, 0xbf810000
.globl recurrent_scan__ssm_conv_s4__dense_activation_mish__prompt_kernel
.p2align 8
.type recurrent_scan__ssm_conv_s4__dense_activation_mish__prompt_kernel,@function
recurrent_scan__ssm_conv_s4__dense_activation_mish__prompt_kernel:
    s_load_dwordx16 s[4:19], s[0:1], 0
    s_load_dwordx16 s[20:35], s[0:1], 64
    s_cmp_ge_u32 s2, 256
    s_cbranch_scc1 L_exit
    v_lshrrev_b32 v1, 6, v0
    v_and_b32_e64 v0, 63, v0
    v_readfirstlane_b32 s54, v1
    s_and_b32 s55, s2, 7
    s_lshr_b32 s56, s2, 3
    s_getpc_b64 s[48:49]
L_pc:
    s_mov_b32 s50, L_end-L_pc
    s_mov_b32 s51, 0x20000
    s_lshl3_add_u32 s62, s56, s54
    s_lshl_b32 s62, s62, 7
    buffer_load_dword v255, off, s[48:51], s62 offset:1024
    s_mov_b32 s46, 16777216
    s_mov_b32 s47, 0x20000
    s_cmp_ge_u32 s56, 28
    s_cbranch_scc1 L_helper
    s_mul_i32 s3, s56, 37
    s_lshr_b32 s3, s3, 8
    s_mul_i32 s62, s3, 7
    s_sub_u32 s61, s56, s62
    s_lshr_b32 s57, s55, 1
    s_lshl2_add_u32 s57, s57, s3
    s_and_b32 s59, s55, 1
    s_cmp_lt_u32 s54, 4
    s_cbranch_scc1 L_common
    s_setprio 1
    s_sub_u32 s70, s54, 4
    s_mul_i32 s97, s55, 28
    s_add_u32 s97, s97, s56
    s_lshl_b32 s62, s97, 2
    s_add_u32 s73, s62, s70
    s_lshl_b32 s73, s73, 8
    v_lshl_add_u32 v50, v0, 2, s73
    s_waitcnt lgkmcnt(0)
    s_load_dword s71, s[18:19], s62
    global_load_dword v10, v50, s[6:7]
    global_load_dword v11, v50, s[8:9]
    global_load_dword v12, v50, s[10:11]
    global_load_dword v13, v50, s[12:13]
    global_load_dword v14, v50, s[14:15]
    global_load_dword v15, v50, s[16:17]
    s_load_dword s72, s[20:21], s62
    s_setprio 0
L_common:
    s_and_b32 s68, s54, 1
    s_bfe_u32 s69, s54, 0x10001
    s_mul_i32 s58, s59, 7
    s_add_u32 s58, s58, s61
    s_lshl1_add_u32 s62, s57, s69
    s_mul_i32 s62, s62, 57344
    s_mul_i32 s63, s69, 448
    s_add_u32 s63, s63, s58
    s_lshl_b32 s63, s63, 8
    s_lshl1_add_u32 s66, s68, s69
    s_lshl_b32 s66, s66, 13
    s_add_u32 s78, s68, 3
    v_lshrrev_b32 v24, s78, v0
    s_lshl_b32 s78, s68, 1
    v_lshrrev_b32 v25, 4, v0
    v_lshlrev_b32_e64 v25, s78, v25
    s_lshl_b32 s79, 896, s78
    v_xor_b32 v25, v0, v25
    v_mul_u32_u24 v24, s79, v24
    s_cmp_eq_u32 s68, 0
    s_cselect_b32 s64, s62, s63
    s_cselect_b32 s65, 1, 1792
    s_cselect_b32 s78, 7, 15
    s_cselect_b32 s79, 64, 0
    s_cselect_b32 s38, 8, 7
    v_and_b32 v25, s78, v25
    v_lshl_add_u32 v1, v25, 4, v24
    v_xor_b32 v2, s79, v1
    s_lshl_b32 s65, s65, 7
    s_and_b32 s56, s55, 6
    s_mul_i32 s62, s56, s65
    s_add_u32 s64, s64, s62
    s_mul_i32 s67, s65, 7
    s_mul_i32 s38, s38, 229376
    s_mov_b32 s39, 0x20000
    s_lshl_b32 s79, 7168, s68
    s_sub_u32 s62, s79, 1024
    v_add_u32 v2, s62, v2
    s_lshl_b32 s62, s62, 1
    v_add_u32 v3, s62, v1
    v_add_u32 v4, s62, v2
    s_lshl_b32 s62, s79, 2
    s_lshl_b32 s78, s68, 5
    v_xor_b32 v3, s78, v3
    v_xor_b32 v4, s78, v4
    v_add_u32 v5, s62, v1
    v_add_u32 v6, s62, v2
    v_add_u32 v7, s62, v3
    v_add_u32 v8, s62, v4
    s_cmp_ge_u32 s54, 4
    s_cbranch_scc1 L_roleB
    s_cmp_eq_u32 s68, 0
    s_waitcnt lgkmcnt(0)
    s_cselect_b32 s36, s4, s24
    s_cselect_b32 s37, s5, s25
    s_add_u32 m0, s66, 98304
    s_nop 0
    buffer_load_dwordx4 v1, s[36:39], s64 offen offset:0 lds
    buffer_load_dwordx4 v2, s[36:39], s64 offen offset:1024 lds
    buffer_load_dwordx4 v3, s[36:39], s64 offen offset:2048 lds
    buffer_load_dwordx4 v4, s[36:39], s64 offen offset:3072 lds
    s_add_u32 m0, s66, 102400
    s_nop 0
    buffer_load_dwordx4 v5, s[36:39], s64 offen offset:0 lds
    buffer_load_dwordx4 v6, s[36:39], s64 offen offset:1024 lds
    buffer_load_dwordx4 v7, s[36:39], s64 offen offset:2048 lds
    buffer_load_dwordx4 v8, s[36:39], s64 offen offset:3072 lds
    s_add_u32 s64, s64, s65
    s_cmp_eq_u32 s56, 6
    s_cselect_b32 s62, s67, 0
    s_sub_u32 s64, s64, s62
    s_add_u32 m0, s66, 131072
    s_nop 0
    buffer_load_dwordx4 v1, s[36:39], s64 offen offset:0 lds
    buffer_load_dwordx4 v2, s[36:39], s64 offen offset:1024 lds
    buffer_load_dwordx4 v3, s[36:39], s64 offen offset:2048 lds
    buffer_load_dwordx4 v4, s[36:39], s64 offen offset:3072 lds
    s_load_dword s52, s[34:35], 0
    s_mov_b32 s44, s34
    s_mov_b32 s45, s35
    s_mov_b64 exec, 0
    s_cmp_eq_u32 s54, 3
    s_cbranch_scc1 L_hop0
    s_branch L_bodyA
L_helper:
    s_lshl2_add_u32 s64, s55, s56
    s_sub_u32 s64, s64, 28
    s_lshl3_add_u32 s72, s64, s54
    s_mul_i32 s65, s72, 7168
    v_lshrrev_b32 v3, 3, v0
    v_mul_u32_u24 v1, 896, v3
    v_and_b32 v2, 7, v0
    v_lshl_add_u32 v1, v2, 4, v1
    s_waitcnt lgkmcnt(0)
    s_mov_b32 s36, s4
    s_mov_b32 s37, s5
    s_mov_b32 s38, 1835008
    s_mov_b32 s39, 0x20000
    buffer_load_dwordx4 v[16:19], v1, s[36:39], s65 offen offset:0
    buffer_load_dwordx4 v[20:23], v1, s[36:39], s65 offen offset:128
    buffer_load_dwordx4 v[24:27], v1, s[36:39], s65 offen offset:256
    buffer_load_dwordx4 v[28:31], v1, s[36:39], s65 offen offset:384
    buffer_load_dwordx4 v[32:35], v1, s[36:39], s65 offen offset:512
    buffer_load_dwordx4 v[36:39], v1, s[36:39], s65 offen offset:640
    buffer_load_dwordx4 v[40:43], v1, s[36:39], s65 offen offset:768
    s_branch L_bodyH
L_roleB:
    s_load_dword s52, s[34:35], 0
    s_mov_b32 s44, s34
    s_mov_b32 s45, s35
    s_cmp_eq_u32 s68, 0
    s_cselect_b32 s36, s4, s24
    s_cselect_b32 s37, s5, s25
    s_cmp_ge_u32 s56, 3
    s_cselect_b32 s62, -3, 4
    s_mul_i32 s62, s62, s65
    s_add_u32 s64, s64, s62
    v_lshlrev_b32 v9, 4, v0
    s_lshl3_add_u32 s73, s73, 3145728
    s_mov_b32 s40, s28
    s_mov_b32 s41, s29
    s_mov_b32 s42, 1605632
    s_mov_b32 s43, 0x20000
    s_lshl2_add_u32 s60, s55, s3
    s_lshr_b32 s62, s97, 5
    s_lshl2_add_u32 s74, s62, s70
    s_and_b32 s62, s97, 3
    s_lshl2_add_u32 s74, s74, s62
    s_lshl_b32 s74, s74, 7
    s_add_u32 s74, s74, 4096
    s_lshr_b32 s62, s97, 4
    s_mul_i32 s75, s97, 9216
    s_lshl_b32 s63, s70, 10
    s_add_u32 s75, s75, s63
    s_add_u32 s75, s75, 262144
    s_mul_i32 s76, s70, 14
    s_add_u32 s76, s76, s62
    s_lshl_b32 s76, s76, 7
    s_and_b32 s63, s97, 15
    s_add_u32 s76, s76, s63
    s_lshl2_add_u32 s76, s76, 32768
    s_lshl1_add_u32 s62, s61, s69
    s_lshr_b32 s63, s60, 3
    s_mul_i32 s77, s63, 14
    s_add_u32 s77, s77, s62
    s_lshl2_add_u32 s77, s77, s3
    s_lshl_b32 s77, s77, 7
    s_add_u32 s77, s77, 32768
    s_lshl_b32 s58, s62, 9
    s_add_u32 s58, s58, s60
    s_lshl1_add_u32 s58, s58, s68
    s_lshl_b32 s58, s58, 7
    s_add_u32 s58, s58, 3145728
    v_and_b32 v50, 15, v0
    v_lshrrev_b32 v51, 4, v0
    s_mul_i32 s62, s70, 8448
    v_mul_u32_u24 v52, 528, v50
    v_and_b32 v53, 256, v9
    v_add3_u32 v52, v52, v53, s62
    v_lshrrev_b32_e64 v53, 5, v0
    v_lshl_add_u32 v47, v53, 4, v52
    s_lshl_b32 s62, s70, 13
    v_add_u32 v40, s62, v9
    s_mul_i32 s62, s70, 3072
    s_add_u32 s62, s62, 33792
    v_add_u32_e64 v32, s62, v9
    s_mul_i32 s62, s69, 9472
    s_add_u32 s62, s62, 512
    s_lshl_b32 s63, s68, 10
    s_add_u32 s63, s63, s62
    v_add_u32 v33, s63, v9
    v_sub_u32 v52, 3, v50
    v_and_b32_e64 v52, 3, v52
    v_mul_u32_u24 v53, 2238, v52
    v_lshl_add_u32 v53, v51, 4, v53
    v_lshlrev_b32 v52, 1, v50
    v_sub_u32 v53, v53, v52
    s_lshl_b32 s63, s68, 8
    s_sub_u32 s62, s62, s63
    s_add_u32 s62, s62, 30
    v_add_u32 v35, s62, v53
    s_mul_i32 s78, s69, 4608
    s_sub_u32 s62, s78, s63
    s_add_u32 s62, s62, 19744
    v_lshlrev_b32 v52, 5, v50
    v_lshl_add_u32 v52, v51, 4, v52
    v_add_u32 v36, s62, v52
    s_add_u32 s78, s78, s63
    s_add_u32 s78, s78, 19456
    v_lshl_add_u32 v43, v0, 2, s78
    s_lshl_b32 s62, s70, 10
    s_add_u32 s62, s62, 19968
    v_add_u32 v37, s62, v9
    s_lshl_b32 s62, s70, 11
    s_add_u32 s62, s62, 0
    v_add_u32 v41, s62, v9
    v_mov_b32 v56, 0
    v_mov_b32 v57, 0
    v_mov_b32 v58, 0
    v_mov_b32 v59, 0
    s_lshl2_add_u32 s62, s70, 64512
    v_mov_b32 v39, s62
    v_and_b32 v38, 3, v0
    v_lshlrev_b32 v38, 2, v38
    v_add_u32 v38, 64512, v38
    v_lshrrev_b32_e64 v52, 3, v0
    v_mul_u32_u24 v52, 896, v52
    v_bfe_u32 v53, v0, 4, 2
    v_lshlrev_b32 v53, 1, v53
    v_xor_b32 v53, v0, v53
    v_and_b32_e64 v53, 7, v53
    v_lshl_add_u32 v48, v53, 4, v52
    v_add_u32 v49, 6144, v48
    s_mov_b32 s89, 0
    s_mul_i32 s88, s70, 7
    s_add_u32 s88, s88, s89
    s_mul_i32 s88, s88, 448
    s_add_u32 s88, s88, s61
    s_lshl_b32 s88, s88, 7
    s_lshl_b32 s91, s70, 13
    s_add_u32 s91, s91, 65536
    s_lshl2_add_u32 s92, s97, s70
    s_mul_i32 s92, s92, 1792
    s_add_u32 s92, s92, 60
    s_waitcnt lgkmcnt(0)
    s_add_u32 s52, s52, 2654435761
    s_mov_b32 s53, s52
    s_lshl_b32 s90, s69, 4
    s_lshr_b32 s71, s71, s90
    s_lshl_b32 s71, s71, 16
    s_lshr_b32 s72, s72, s90
    s_lshl_b32 s72, s72, 16
    v_mov_b32 v60, 1069066811
    v_mul_f32 v60, s71, v60
    v_exp_f32 v60, v60
    v_mov_b32 v42, s52
    v_cvt_pk_bf16_f32 v60, v60, v60
    v_and_b32 v60, 0xffff0000, v60
    v_mov_b32_e64 v61, v60
    s_buffer_load_dwordx2 s[94:95], s[40:43], s92
    s_add_u32 s92, s92, 128
    s_buffer_load_dwordx2 s[94:95], s[40:43], s92
    s_add_u32 s92, s92, 128
    s_buffer_load_dwordx2 s[94:95], s[40:43], s92
    s_add_u32 s92, s92, 128
    s_buffer_load_dwordx2 s[94:95], s[40:43], s92
    s_add_u32 s92, s92, 128
    s_buffer_load_dwordx2 s[94:95], s[40:43], s92
    s_add_u32 s92, s92, 128
    s_buffer_load_dwordx2 s[94:95], s[40:43], s92
    s_add_u32 s92, s92, 128
    s_buffer_load_dwordx2 s[94:95], s[40:43], s92
    s_add_u32 s92, s92, 128
    v_mov_b32 v128, 0x3f80
    v_mov_b32 v129, 0x3f80
    s_waitcnt vmcnt(5)
    v_lshlrev_b32 v108, 16, v10
    v_and_b32 v109, 0xffff0000, v10
    s_waitcnt vmcnt(4)
    v_lshlrev_b32 v110, 16, v11
    v_and_b32 v111, 0xffff0000, v11
    v_pk_mul_f32 v[108:109], v[108:109], v[60:61]
    v_pk_mul_f32 v[110:111], v[110:111], v[60:61]
    v_mul_f32 v108, 1069066811, v108
    v_mul_f32 v110, 0.15915494, v110
    v_mul_f32 v109, 1069066811, v109
    v_mul_f32 v111, 0.15915494, v111
    v_ldexp_f32 v96, v108, 3
    v_ldexp_f32 v98, v110, 3
    v_exp_f32 v96, v96
    v_fract_f32 v98, v98
    v_ldexp_f32 v97, v109, 3
    v_ldexp_f32 v99, v111, 3
    v_exp_f32 v97, v97
    v_fract_f32 v99, v99
    v_cos_f32 v76, v98
    v_sin_f32 v78, v98
    v_cos_f32 v77, v99
    v_sin_f32 v79, v99
    v_pk_mul_f32 v[76:77], v[76:77], v[96:97]
    v_pk_mul_f32 v[78:79], v[78:79], v[96:97]
    v_cvt_pk_bf16_f32 v130, v76, v78
    v_cvt_pk_bf16_f32 v131, v77, v79
    v_pk_mul_f32 v[96:97], v[76:77], v[76:77]
    v_pk_mul_f32 v[98:99], v[76:77], v[78:79]
    v_pk_fma_f32 v[84:85], v[78:79], v[78:79], v[96:97] neg_lo:[1,0,0] neg_hi:[1,0,0]
    v_pk_fma_f32 v[86:87], v[78:79], v[76:77], v[98:99]
    v_cvt_pk_bf16_f32 v132, v84, v86
    v_cvt_pk_bf16_f32 v133, v85, v87
    v_pk_mul_f32 v[96:97], v[84:85], v[76:77]
    v_pk_mul_f32 v[98:99], v[84:85], v[78:79]
    v_pk_fma_f32 v[84:85], v[86:87], v[78:79], v[96:97] neg_lo:[1,0,0] neg_hi:[1,0,0]
    v_pk_fma_f32 v[86:87], v[86:87], v[76:77], v[98:99]
    v_cvt_pk_bf16_f32 v134, v84, v86
    v_cvt_pk_bf16_f32 v135, v85, v87
    v_pk_mul_f32 v[96:97], v[84:85], v[76:77]
    v_pk_mul_f32 v[98:99], v[84:85], v[78:79]
    v_pk_fma_f32 v[84:85], v[86:87], v[78:79], v[96:97] neg_lo:[1,0,0] neg_hi:[1,0,0]
    v_pk_fma_f32 v[86:87], v[86:87], v[76:77], v[98:99]
    v_cvt_pk_bf16_f32 v136, v84, v86
    v_cvt_pk_bf16_f32 v137, v85, v87
    v_pk_mul_f32 v[96:97], v[84:85], v[76:77]
    v_pk_mul_f32 v[98:99], v[84:85], v[78:79]
    v_pk_fma_f32 v[84:85], v[86:87], v[78:79], v[96:97] neg_lo:[1,0,0] neg_hi:[1,0,0]
    v_pk_fma_f32 v[86:87], v[86:87], v[76:77], v[98:99]
    v_cvt_pk_bf16_f32 v138, v84, v86
    v_cvt_pk_bf16_f32 v139, v85, v87
    v_pk_mul_f32 v[96:97], v[84:85], v[76:77]
    v_pk_mul_f32 v[98:99], v[84:85], v[78:79]
    v_pk_fma_f32 v[84:85], v[86:87], v[78:79], v[96:97] neg_lo:[1,0,0] neg_hi:[1,0,0]
    v_pk_fma_f32 v[86:87], v[86:87], v[76:77], v[98:99]
    v_cvt_pk_bf16_f32 v140, v84, v86
    v_cvt_pk_bf16_f32 v141, v85, v87
    v_pk_mul_f32 v[96:97], v[84:85], v[76:77]
    v_pk_mul_f32 v[98:99], v[84:85], v[78:79]
    v_pk_fma_f32 v[84:85], v[86:87], v[78:79], v[96:97] neg_lo:[1,0,0] neg_hi:[1,0,0]
    v_pk_fma_f32 v[86:87], v[86:87], v[76:77], v[98:99]
    v_cvt_pk_bf16_f32 v142, v84, v86
    v_cvt_pk_bf16_f32 v143, v85, v87
    v_pk_mul_f32 v[96:97], v[84:85], v[76:77]
    v_pk_mul_f32 v[98:99], v[84:85], v[78:79]
    v_pk_fma_f32 v[84:85], v[86:87], v[78:79], v[96:97] neg_lo:[1,0,0] neg_hi:[1,0,0]
    v_pk_fma_f32 v[86:87], v[86:87], v[76:77], v[98:99]
    v_cvt_pk_bf16_f32 v144, v84, v86
    v_cvt_pk_bf16_f32 v145, v85, v87
    v_pk_mul_f32 v[96:97], v[84:85], v[76:77]
    v_pk_mul_f32 v[98:99], v[84:85], v[78:79]
    v_pk_fma_f32 v[84:85], v[86:87], v[78:79], v[96:97] neg_lo:[1,0,0] neg_hi:[1,0,0]
    v_pk_fma_f32 v[86:87], v[86:87], v[76:77], v[98:99]
    v_cvt_pk_bf16_f32 v146, v84, v86
    v_cvt_pk_bf16_f32 v147, v85, v87
    v_pk_mul_f32 v[96:97], v[84:85], v[76:77]
    v_pk_mul_f32 v[98:99], v[84:85], v[78:79]
    v_pk_fma_f32 v[84:85], v[86:87], v[78:79], v[96:97] neg_lo:[1,0,0] neg_hi:[1,0,0]
    v_pk_fma_f32 v[86:87], v[86:87], v[76:77], v[98:99]
    v_cvt_pk_bf16_f32 v148, v84, v86
    v_cvt_pk_bf16_f32 v149, v85, v87
    v_pk_mul_f32 v[96:97], v[84:85], v[76:77]
    v_pk_mul_f32 v[98:99], v[84:85], v[78:79]
    v_pk_fma_f32 v[84:85], v[86:87], v[78:79], v[96:97] neg_lo:[1,0,0] neg_hi:[1,0,0]
    v_pk_fma_f32 v[86:87], v[86:87], v[76:77], v[98:99]
    v_cvt_pk_bf16_f32 v150, v84, v86
    v_cvt_pk_bf16_f32 v151, v85, v87
    v_pk_mul_f32 v[96:97], v[84:85], v[76:77]
    v_pk_mul_f32 v[98:99], v[84:85], v[78:79]
    v_pk_fma_f32 v[84:85], v[86:87], v[78:79], v[96:97] neg_lo:[1,0,0] neg_hi:[1,0,0]
    v_pk_fma_f32 v[86:87], v[86:87], v[76:77], v[98:99]
    v_cvt_pk_bf16_f32 v152, v84, v86
    v_cvt_pk_bf16_f32 v153, v85, v87
    v_pk_mul_f32 v[96:97], v[84:85], v[76:77]
    v_pk_mul_f32 v[98:99], v[84:85], v[78:79]
    v_pk_fma_f32 v[84:85], v[86:87], v[78:79], v[96:97] neg_lo:[1,0,0] neg_hi:[1,0,0]
    v_pk_fma_f32 v[86:87], v[86:87], v[76:77], v[98:99]
    v_cvt_pk_bf16_f32 v154, v84, v86
    v_cvt_pk_bf16_f32 v155, v85, v87
    v_pk_mul_f32 v[96:97], v[84:85], v[76:77]
    v_pk_mul_f32 v[98:99], v[84:85], v[78:79]
    v_pk_fma_f32 v[84:85], v[86:87], v[78:79], v[96:97] neg_lo:[1,0,0] neg_hi:[1,0,0]
    v_pk_fma_f32 v[86:87], v[86:87], v[76:77], v[98:99]
    v_cvt_pk_bf16_f32 v156, v84, v86
    v_cvt_pk_bf16_f32 v157, v85, v87
    v_pk_mul_f32 v[96:97], v[84:85], v[76:77]
    v_pk_mul_f32 v[98:99], v[84:85], v[78:79]
    v_pk_fma_f32 v[84:85], v[86:87], v[78:79], v[96:97] neg_lo:[1,0,0] neg_hi:[1,0,0]
    v_pk_fma_f32 v[86:87], v[86:87], v[76:77], v[98:99]
    v_cvt_pk_bf16_f32 v158, v84, v86
    v_cvt_pk_bf16_f32 v159, v85, v87
    v_exp_f32 v96, v108
    v_fract_f32 v98, v110
    v_exp_f32 v97, v109
    v_fract_f32 v99, v111
    v_cos_f32 v64, v98
    v_sin_f32 v66, v98
    v_cos_f32 v65, v99
    v_sin_f32 v67, v99
    v_pk_mul_f32 v[64:65], v[64:65], v[96:97]
    v_pk_mul_f32 v[66:67], v[66:67], v[96:97]
    v_ldexp_f32 v96, v108, 7
    v_ldexp_f32 v98, v110, 7
    v_exp_f32 v96, v96
    v_fract_f32 v98, v98
    v_ldexp_f32 v97, v109, 7
    v_ldexp_f32 v99, v111, 7
    v_exp_f32 v97, v97
    v_fract_f32 v99, v99
    v_cos_f32 v80, v98
    v_sin_f32 v82, v98
    v_cos_f32 v81, v99
    v_sin_f32 v83, v99
    v_pk_mul_f32 v[80:81], v[80:81], v[96:97]
    v_pk_mul_f32 v[82:83], v[82:83], v[96:97]
    s_waitcnt vmcnt(3)
    v_lshlrev_b32 v112, 16, v12
    v_and_b32 v113, 0xffff0000, v12
    s_waitcnt vmcnt(2)
    v_lshlrev_b32 v114, 16, v13
    v_and_b32 v115, 0xffff0000, v13
    s_waitcnt vmcnt(1)
    v_lshlrev_b32 v116, 16, v14
    v_and_b32 v117, 0xffff0000, v14
    s_waitcnt vmcnt(0)
    v_lshlrev_b32 v118, 16, v15
    v_and_b32 v119, 0xffff0000, v15
    v_pk_mul_f32 v[96:97], v[112:113], v[116:117]
    v_pk_mul_f32 v[98:99], v[112:113], v[118:119]
    v_pk_fma_f32 v[88:89], v[114:115], v[118:119], v[96:97] neg_lo:[1,0,0] neg_hi:[1,0,0]
    v_pk_fma_f32 v[90:91], v[114:115], v[116:117], v[98:99]
    v_pk_mul_f32 v[88:89], v[88:89], v[60:61]
    v_pk_mul_f32 v[90:91], v[90:91], v[60:61]
    v_pk_mul_f32 v[96:97], v[88:89], v[80:81]
    v_pk_mul_f32 v[98:99], v[88:89], v[82:83]
    v_pk_fma_f32 v[84:85], v[90:91], v[82:83], v[96:97] neg_lo:[1,0,0] neg_hi:[1,0,0]
    v_pk_fma_f32 v[86:87], v[90:91], v[80:81], v[98:99]
    v_cvt_pk_bf16_f32 v160, v88, -v90
    v_cvt_pk_bf16_f32 v161, v89, -v91
    v_cvt_pk_bf16_f32 v176, v84, -v86
    v_cvt_pk_bf16_f32 v177, v85, -v87
    v_pk_mul_f32 v[96:97], v[88:89], v[64:65]
    v_pk_mul_f32 v[98:99], v[88:89], v[66:67]
    v_pk_fma_f32 v[88:89], v[90:91], v[66:67], v[96:97] neg_lo:[1,0,0] neg_hi:[1,0,0]
    v_pk_fma_f32 v[90:91], v[90:91], v[64:65], v[98:99]
    v_cvt_pk_bf16_f32 v162, v88, -v90
    v_cvt_pk_bf16_f32 v163, v89, -v91
    v_pk_mul_f32 v[96:97], v[84:85], v[64:65]
    v_pk_mul_f32 v[98:99], v[84:85], v[66:67]
    v_pk_fma_f32 v[92:93], v[86:87], v[66:67], v[96:97] neg_lo:[1,0,0] neg_hi:[1,0,0]
    v_pk_fma_f32 v[94:95], v[86:87], v[64:65], v[98:99]
    v_cvt_pk_bf16_f32 v178, v92, -v94
    v_cvt_pk_bf16_f32 v179, v93, -v95
    v_pk_mul_f32 v[96:97], v[88:89], v[64:65]
    v_pk_mul_f32 v[98:99], v[88:89], v[66:67]
    v_pk_fma_f32 v[88:89], v[90:91], v[66:67], v[96:97] neg_lo:[1,0,0] neg_hi:[1,0,0]
    v_pk_fma_f32 v[90:91], v[90:91], v[64:65], v[98:99]
    v_cvt_pk_bf16_f32 v164, v88, -v90
    v_cvt_pk_bf16_f32 v165, v89, -v91
    v_pk_mul_f32 v[96:97], v[92:93], v[64:65]
    v_pk_mul_f32 v[98:99], v[92:93], v[66:67]
    v_pk_fma_f32 v[92:93], v[94:95], v[66:67], v[96:97] neg_lo:[1,0,0] neg_hi:[1,0,0]
    v_pk_fma_f32 v[94:95], v[94:95], v[64:65], v[98:99]
    v_cvt_pk_bf16_f32 v180, v92, -v94
    v_cvt_pk_bf16_f32 v181, v93, -v95
    v_pk_mul_f32 v[96:97], v[88:89], v[64:65]
    v_pk_mul_f32 v[98:99], v[88:89], v[66:67]
    v_pk_fma_f32 v[88:89], v[90:91], v[66:67], v[96:97] neg_lo:[1,0,0] neg_hi:[1,0,0]
    v_pk_fma_f32 v[90:91], v[90:91], v[64:65], v[98:99]
    v_cvt_pk_bf16_f32 v166, v88, -v90
    v_cvt_pk_bf16_f32 v167, v89, -v91
    v_pk_mul_f32 v[96:97], v[92:93], v[64:65]
    v_pk_mul_f32 v[98:99], v[92:93], v[66:67]
    v_pk_fma_f32 v[92:93], v[94:95], v[66:67], v[96:97] neg_lo:[1,0,0] neg_hi:[1,0,0]
    v_pk_fma_f32 v[94:95], v[94:95], v[64:65], v[98:99]
    v_cvt_pk_bf16_f32 v182, v92, -v94
    v_cvt_pk_bf16_f32 v183, v93, -v95
    v_pk_mul_f32 v[96:97], v[88:89], v[64:65]
    v_pk_mul_f32 v[98:99], v[88:89], v[66:67]
    v_pk_fma_f32 v[88:89], v[90:91], v[66:67], v[96:97] neg_lo:[1,0,0] neg_hi:[1,0,0]
    v_pk_fma_f32 v[90:91], v[90:91], v[64:65], v[98:99]
    v_cvt_pk_bf16_f32 v168, v88, -v90
    v_cvt_pk_bf16_f32 v169, v89, -v91
    v_pk_mul_f32 v[96:97], v[92:93], v[64:65]
    v_pk_mul_f32 v[98:99], v[92:93], v[66:67]
    v_pk_fma_f32 v[92:93], v[94:95], v[66:67], v[96:97] neg_lo:[1,0,0] neg_hi:[1,0,0]
    v_pk_fma_f32 v[94:95], v[94:95], v[64:65], v[98:99]
    v_cvt_pk_bf16_f32 v184, v92, -v94
    v_cvt_pk_bf16_f32 v185, v93, -v95
    v_pk_mul_f32 v[96:97], v[88:89], v[64:65]
    v_pk_mul_f32 v[98:99], v[88:89], v[66:67]
    v_pk_fma_f32 v[88:89], v[90:91], v[66:67], v[96:97] neg_lo:[1,0,0] neg_hi:[1,0,0]
    v_pk_fma_f32 v[90:91], v[90:91], v[64:65], v[98:99]
    v_cvt_pk_bf16_f32 v170, v88, -v90
    v_cvt_pk_bf16_f32 v171, v89, -v91
    v_pk_mul_f32 v[96:97], v[92:93], v[64:65]
    v_pk_mul_f32 v[98:99], v[92:93], v[66:67]
    v_pk_fma_f32 v[92:93], v[94:95], v[66:67], v[96:97] neg_lo:[1,0,0] neg_hi:[1,0,0]
    v_pk_fma_f32 v[94:95], v[94:95], v[64:65], v[98:99]
    v_cvt_pk_bf16_f32 v186, v92, -v94
    v_cvt_pk_bf16_f32 v187, v93, -v95
    v_pk_mul_f32 v[96:97], v[88:89], v[64:65]
    v_pk_mul_f32 v[98:99], v[88:89], v[66:67]
    v_pk_fma_f32 v[88:89], v[90:91], v[66:67], v[96:97] neg_lo:[1,0,0] neg_hi:[1,0,0]
    v_pk_fma_f32 v[90:91], v[90:91], v[64:65], v[98:99]
    v_cvt_pk_bf16_f32 v172, v88, -v90
    v_cvt_pk_bf16_f32 v173, v89, -v91
    v_pk_mul_f32 v[96:97], v[92:93], v[64:65]
    v_pk_mul_f32 v[98:99], v[92:93], v[66:67]
    v_pk_fma_f32 v[92:93], v[94:95], v[66:67], v[96:97] neg_lo:[1,0,0] neg_hi:[1,0,0]
    v_pk_fma_f32 v[94:95], v[94:95], v[64:65], v[98:99]
    v_cvt_pk_bf16_f32 v188, v92, -v94
    v_cvt_pk_bf16_f32 v189, v93, -v95
    v_pk_mul_f32 v[96:97], v[88:89], v[64:65]
    v_pk_mul_f32 v[98:99], v[88:89], v[66:67]
    v_pk_fma_f32 v[88:89], v[90:91], v[66:67], v[96:97] neg_lo:[1,0,0] neg_hi:[1,0,0]
    v_pk_fma_f32 v[90:91], v[90:91], v[64:65], v[98:99]
    v_cvt_pk_bf16_f32 v174, v88, -v90
    v_cvt_pk_bf16_f32 v175, v89, -v91
    v_pk_mul_f32 v[96:97], v[92:93], v[64:65]
    v_pk_mul_f32 v[98:99], v[92:93], v[66:67]
    v_pk_fma_f32 v[92:93], v[94:95], v[66:67], v[96:97] neg_lo:[1,0,0] neg_hi:[1,0,0]
    v_pk_fma_f32 v[94:95], v[94:95], v[64:65], v[98:99]
    v_cvt_pk_bf16_f32 v190, v92, -v94
    v_cvt_pk_bf16_f32 v191, v93, -v95
    v_pk_mul_f32 v[96:97], v[64:65], v[64:65]
    v_pk_mul_f32 v[98:99], v[64:65], v[66:67]
    v_pk_fma_f32 v[68:69], v[66:67], v[66:67], v[96:97] neg_lo:[1,0,0] neg_hi:[1,0,0]
    v_pk_fma_f32 v[70:71], v[66:67], v[64:65], v[98:99]
    v_pk_mul_f32 v[96:97], v[68:69], v[68:69]
    v_pk_mul_f32 v[98:99], v[68:69], v[70:71]
    v_pk_fma_f32 v[72:73], v[70:71], v[70:71], v[96:97] neg_lo:[1,0,0] neg_hi:[1,0,0]
    v_pk_fma_f32 v[74:75], v[70:71], v[68:69], v[98:99]
    v_pk_mul_f32 v[96:97], v[84:85], v[80:81]
    v_pk_mul_f32 v[98:99], v[84:85], v[82:83]
    v_pk_fma_f32 v[84:85], v[86:87], v[82:83], v[96:97] neg_lo:[1,0,0] neg_hi:[1,0,0]
    v_pk_fma_f32 v[86:87], v[86:87], v[80:81], v[98:99]
    v_cvt_pk_bf16_f32 v192, v84, -v86
    v_cvt_pk_bf16_f32 v193, v85, -v87
    v_pk_mul_f32 v[96:97], v[84:85], v[68:69]
    v_pk_mul_f32 v[98:99], v[84:85], v[70:71]
    v_pk_fma_f32 v[88:89], v[86:87], v[70:71], v[96:97] neg_lo:[1,0,0] neg_hi:[1,0,0]
    v_pk_fma_f32 v[90:91], v[86:87], v[68:69], v[98:99]
    v_cvt_pk_bf16_f32 v194, v88, -v90
    v_cvt_pk_bf16_f32 v195, v89, -v91
    v_pk_mul_f32 v[96:97], v[88:89], v[68:69]
    v_pk_mul_f32 v[98:99], v[88:89], v[70:71]
    v_pk_fma_f32 v[88:89], v[90:91], v[70:71], v[96:97] neg_lo:[1,0,0] neg_hi:[1,0,0]
    v_pk_fma_f32 v[90:91], v[90:91], v[68:69], v[98:99]
    v_cvt_pk_bf16_f32 v196, v88, -v90
    v_cvt_pk_bf16_f32 v197, v89, -v91
    v_pk_mul_f32 v[96:97], v[88:89], v[68:69]
    v_pk_mul_f32 v[98:99], v[88:89], v[70:71]
    v_pk_fma_f32 v[88:89], v[90:91], v[70:71], v[96:97] neg_lo:[1,0,0] neg_hi:[1,0,0]
    v_pk_fma_f32 v[90:91], v[90:91], v[68:69], v[98:99]
    v_cvt_pk_bf16_f32 v198, v88, -v90
    v_cvt_pk_bf16_f32 v199, v89, -v91
    v_pk_mul_f32 v[96:97], v[84:85], v[80:81]
    v_pk_mul_f32 v[98:99], v[84:85], v[82:83]
    v_pk_fma_f32 v[84:85], v[86:87], v[82:83], v[96:97] neg_lo:[1,0,0] neg_hi:[1,0,0]
    v_pk_fma_f32 v[86:87], v[86:87], v[80:81], v[98:99]
    v_cvt_pk_bf16_f32 v200, v84, -v86
    v_cvt_pk_bf16_f32 v201, v85, -v87
    v_pk_mul_f32 v[96:97], v[84:85], v[68:69]
    v_pk_mul_f32 v[98:99], v[84:85], v[70:71]
    v_pk_fma_f32 v[88:89], v[86:87], v[70:71], v[96:97] neg_lo:[1,0,0] neg_hi:[1,0,0]
    v_pk_fma_f32 v[90:91], v[86:87], v[68:69], v[98:99]
    v_cvt_pk_bf16_f32 v202, v88, -v90
    v_cvt_pk_bf16_f32 v203, v89, -v91
    v_pk_mul_f32 v[96:97], v[88:89], v[68:69]
    v_pk_mul_f32 v[98:99], v[88:89], v[70:71]
    v_pk_fma_f32 v[88:89], v[90:91], v[70:71], v[96:97] neg_lo:[1,0,0] neg_hi:[1,0,0]
    v_pk_fma_f32 v[90:91], v[90:91], v[68:69], v[98:99]
    v_cvt_pk_bf16_f32 v204, v88, -v90
    v_cvt_pk_bf16_f32 v205, v89, -v91
    v_pk_mul_f32 v[96:97], v[88:89], v[68:69]
    v_pk_mul_f32 v[98:99], v[88:89], v[70:71]
    v_pk_fma_f32 v[88:89], v[90:91], v[70:71], v[96:97] neg_lo:[1,0,0] neg_hi:[1,0,0]
    v_pk_fma_f32 v[90:91], v[90:91], v[68:69], v[98:99]
    v_cvt_pk_bf16_f32 v206, v88, -v90
    v_cvt_pk_bf16_f32 v207, v89, -v91
    v_pk_mul_f32 v[96:97], v[84:85], v[80:81]
    v_pk_mul_f32 v[98:99], v[84:85], v[82:83]
    v_pk_fma_f32 v[84:85], v[86:87], v[82:83], v[96:97] neg_lo:[1,0,0] neg_hi:[1,0,0]
    v_pk_fma_f32 v[86:87], v[86:87], v[80:81], v[98:99]
    v_cvt_pk_bf16_f32 v208, v84, -v86
    v_cvt_pk_bf16_f32 v209, v85, -v87
    v_pk_mul_f32 v[96:97], v[84:85], v[72:73]
    v_pk_mul_f32 v[98:99], v[84:85], v[74:75]
    v_pk_fma_f32 v[88:89], v[86:87], v[74:75], v[96:97] neg_lo:[1,0,0] neg_hi:[1,0,0]
    v_pk_fma_f32 v[90:91], v[86:87], v[72:73], v[98:99]
    v_cvt_pk_bf16_f32 v210, v88, -v90
    v_cvt_pk_bf16_f32 v211, v89, -v91
    v_pk_mul_f32 v[96:97], v[84:85], v[80:81]
    v_pk_mul_f32 v[98:99], v[84:85], v[82:83]
    v_pk_fma_f32 v[84:85], v[86:87], v[82:83], v[96:97] neg_lo:[1,0,0] neg_hi:[1,0,0]
    v_pk_fma_f32 v[86:87], v[86:87], v[80:81], v[98:99]
    v_cvt_pk_bf16_f32 v212, v84, -v86
    v_cvt_pk_bf16_f32 v213, v85, -v87
    v_pk_mul_f32 v[96:97], v[84:85], v[72:73]
    v_pk_mul_f32 v[98:99], v[84:85], v[74:75]
L_hop0:
    s_cbranch_execz L_bodyA
    s_nop 0
    v_pk_fma_f32 v[88:89], v[86:87], v[74:75], v[96:97] neg_lo:[1,0,0] neg_hi:[1,0,0]
    v_pk_fma_f32 v[90:91], v[86:87], v[72:73], v[98:99]
    v_cvt_pk_bf16_f32 v214, v88, -v90
    v_cvt_pk_bf16_f32 v215, v89, -v91
    v_pk_mul_f32 v[96:97], v[84:85], v[80:81]
    v_pk_mul_f32 v[98:99], v[84:85], v[82:83]
    v_pk_fma_f32 v[84:85], v[86:87], v[82:83], v[96:97] neg_lo:[1,0,0] neg_hi:[1,0,0]
    v_pk_fma_f32 v[86:87], v[86:87], v[80:81], v[98:99]
    v_cvt_pk_bf16_f32 v216, v84, -v86
    v_cvt_pk_bf16_f32 v217, v85, -v87
    v_pk_mul_f32 v[96:97], v[84:85], v[72:73]
    v_pk_mul_f32 v[98:99], v[84:85], v[74:75]
    v_pk_fma_f32 v[88:89], v[86:87], v[74:75], v[96:97] neg_lo:[1,0,0] neg_hi:[1,0,0]
    v_pk_fma_f32 v[90:91], v[86:87], v[72:73], v[98:99]
    v_cvt_pk_bf16_f32 v218, v88, -v90
    v_cvt_pk_bf16_f32 v219, v89, -v91
    v_pk_mul_f32 v[96:97], v[84:85], v[80:81]
    v_pk_mul_f32 v[98:99], v[84:85], v[82:83]
    v_pk_fma_f32 v[84:85], v[86:87], v[82:83], v[96:97] neg_lo:[1,0,0] neg_hi:[1,0,0]
    v_pk_fma_f32 v[86:87], v[86:87], v[80:81], v[98:99]
    v_cvt_pk_bf16_f32 v220, v84, -v86
    v_cvt_pk_bf16_f32 v221, v85, -v87
    v_pk_mul_f32 v[96:97], v[84:85], v[72:73]
    v_pk_mul_f32 v[98:99], v[84:85], v[74:75]
    v_pk_fma_f32 v[88:89], v[86:87], v[74:75], v[96:97] neg_lo:[1,0,0] neg_hi:[1,0,0]
    v_pk_fma_f32 v[90:91], v[86:87], v[72:73], v[98:99]
    v_cvt_pk_bf16_f32 v222, v88, -v90
    v_cvt_pk_bf16_f32 v223, v89, -v91
    v_pk_mul_f32 v[96:97], v[84:85], v[80:81]
    v_pk_mul_f32 v[98:99], v[84:85], v[82:83]
    v_pk_fma_f32 v[84:85], v[86:87], v[82:83], v[96:97] neg_lo:[1,0,0] neg_hi:[1,0,0]
    v_pk_fma_f32 v[86:87], v[86:87], v[80:81], v[98:99]
    v_cvt_pk_bf16_f32 v224, v84, -v86
    v_cvt_pk_bf16_f32 v225, v85, -v87
    v_pk_mul_f32 v[96:97], v[84:85], v[80:81]
    v_pk_mul_f32 v[98:99], v[84:85], v[82:83]
    v_pk_fma_f32 v[84:85], v[86:87], v[82:83], v[96:97] neg_lo:[1,0,0] neg_hi:[1,0,0]
    v_pk_fma_f32 v[86:87], v[86:87], v[80:81], v[98:99]
    v_cvt_pk_bf16_f32 v226, v84, -v86
    v_cvt_pk_bf16_f32 v227, v85, -v87
    v_pk_mul_f32 v[96:97], v[84:85], v[80:81]
    v_pk_mul_f32 v[98:99], v[84:85], v[82:83]
    v_pk_fma_f32 v[84:85], v[86:87], v[82:83], v[96:97] neg_lo:[1,0,0] neg_hi:[1,0,0]
    v_pk_fma_f32 v[86:87], v[86:87], v[80:81], v[98:99]
    v_cvt_pk_bf16_f32 v228, v84, -v86
    v_cvt_pk_bf16_f32 v229, v85, -v87
    v_pk_mul_f32 v[96:97], v[84:85], v[80:81]
    v_pk_mul_f32 v[98:99], v[84:85], v[82:83]
    v_pk_fma_f32 v[84:85], v[86:87], v[82:83], v[96:97] neg_lo:[1,0,0] neg_hi:[1,0,0]
    v_pk_fma_f32 v[86:87], v[86:87], v[80:81], v[98:99]
    v_cvt_pk_bf16_f32 v230, v84, -v86
    v_cvt_pk_bf16_f32 v231, v85, -v87
    v_pk_mul_f32 v[96:97], v[84:85], v[80:81]
    v_pk_mul_f32 v[98:99], v[84:85], v[82:83]
    v_pk_fma_f32 v[84:85], v[86:87], v[82:83], v[96:97] neg_lo:[1,0,0] neg_hi:[1,0,0]
    v_pk_fma_f32 v[86:87], v[86:87], v[80:81], v[98:99]
    v_cvt_pk_bf16_f32 v232, v84, -v86
    v_cvt_pk_bf16_f32 v233, v85, -v87
    v_pk_mul_f32 v[96:97], v[84:85], v[80:81]
    v_pk_mul_f32 v[98:99], v[84:85], v[82:83]
    v_pk_fma_f32 v[84:85], v[86:87], v[82:83], v[96:97] neg_lo:[1,0,0] neg_hi:[1,0,0]
    v_pk_fma_f32 v[86:87], v[86:87], v[80:81], v[98:99]
    v_cvt_pk_bf16_f32 v234, v84, -v86
    v_cvt_pk_bf16_f32 v235, v85, -v87
    v_pk_mul_f32 v[96:97], v[84:85], v[80:81]
    v_pk_mul_f32 v[98:99], v[84:85], v[82:83]
    v_pk_fma_f32 v[84:85], v[86:87], v[82:83], v[96:97] neg_lo:[1,0,0] neg_hi:[1,0,0]
    v_pk_fma_f32 v[86:87], v[86:87], v[80:81], v[98:99]
    v_cvt_pk_bf16_f32 v236, v84, -v86
    v_cvt_pk_bf16_f32 v237, v85, -v87
    v_pk_mul_f32 v[96:97], v[84:85], v[80:81]
    v_pk_mul_f32 v[98:99], v[84:85], v[82:83]
    v_pk_fma_f32 v[84:85], v[86:87], v[82:83], v[96:97] neg_lo:[1,0,0] neg_hi:[1,0,0]
    v_pk_fma_f32 v[86:87], v[86:87], v[80:81], v[98:99]
    v_cvt_pk_bf16_f32 v238, v84, -v86
    v_cvt_pk_bf16_f32 v239, v85, -v87
    v_pk_mul_f32 v[96:97], v[84:85], v[80:81]
    v_pk_mul_f32 v[98:99], v[84:85], v[82:83]
    v_pk_fma_f32 v[84:85], v[86:87], v[82:83], v[96:97] neg_lo:[1,0,0] neg_hi:[1,0,0]
    v_pk_fma_f32 v[86:87], v[86:87], v[80:81], v[98:99]
    v_cvt_pk_bf16_f32 v240, v84, -v86
    v_cvt_pk_bf16_f32 v241, v85, -v87
    s_barrier
    s_buffer_load_dwordx2 s[94:95], s[40:43], s92
    s_add_u32 s92, s92, 128
    s_buffer_load_dwordx2 s[94:95], s[40:43], s92
    s_add_u32 s92, s92, 128
    s_buffer_load_dwordx2 s[94:95], s[40:43], s92
    s_add_u32 s92, s92, 128
    s_buffer_load_dwordx2 s[94:95], s[40:43], s92
    s_add_u32 s92, s92, 128
    s_buffer_load_dwordx2 s[94:95], s[40:43], s92
    s_add_u32 s92, s92, 128
    s_buffer_load_dwordx2 s[94:95], s[40:43], s92
    s_add_u32 s92, s92, 128
    s_buffer_load_dwordx2 s[94:95], s[40:43], s92
    s_add_u32 s92, s92, 128
    v_and_b32 v50, 15, v0
    v_lshrrev_b32 v51, 4, v0
    s_add_u32 m0, s91, -65536
    s_nop 0
    buffer_load_dwordx4 v48, s[40:43], s88 offen lds
    v_lshlrev_b32 v52, 3, v51
    s_movk_i32 s79, 0x3f80
    buffer_load_dwordx4 v49, s[40:43], s88 offen offset:1024 lds
    s_add_u32 s88, s88, 14336
    v_mov_b32 v53, 8176
    v_lshlrev_b32 v53, v50, v53
    s_add_u32 m0, s91, -63488
    s_nop 0
    buffer_load_dwordx4 v48, s[40:43], s88 offen lds
    v_lshrrev_b32_e64 v53, v52, v53
    buffer_load_dwordx4 v49, s[40:43], s88 offen offset:1024 lds
    s_add_u32 s88, s88, 14336
    v_bfe_u32 v54, v53, 0, 1
    v_bfe_u32 v55, v53, 1, 1
    s_add_u32 m0, s91, -61440
    s_nop 0
    buffer_load_dwordx4 v48, s[40:43], s88 offen lds
    v_lshl_or_b32 v54, v55, 16, v54
    v_mul_u32_u24 v12, s79, v54
    buffer_load_dwordx4 v49, s[40:43], s88 offen offset:1024 lds
    s_add_u32 s88, s88, 14336
    v_bfe_u32 v54, v53, 2, 1
    v_bfe_u32 v55, v53, 3, 1
    s_add_u32 m0, s91, -59392
    s_nop 0
    buffer_load_dwordx4 v48, s[40:43], s88 offen lds
    v_lshl_or_b32 v54, v55, 16, v54
    buffer_load_dwordx4 v49, s[40:43], s88 offen offset:1024 lds
    s_add_u32 s88, s88, 14336
    s_barrier
    v_mul_u32_u24_e64 v13, s79, v54
    v_bfe_u32 v54, v53, 4, 1
    s_add_u32 m0, s66, 98304
    s_nop 0
    buffer_load_dwordx4 v1, s[36:39], s64 offen offset:0 lds
    v_bfe_u32 v55, v53, 5, 1
    v_lshl_or_b32 v54, v55, 16, v54
    buffer_load_dwordx4 v2, s[36:39], s64 offen offset:1024 lds
    v_mul_u32_u24 v14, s79, v54
    v_bfe_u32 v54, v53, 6, 1
    buffer_load_dwordx4 v3, s[36:39], s64 offen offset:2048 lds
    v_bfe_u32 v55, v53, 7, 1
    v_lshl_or_b32 v54, v55, 16, v54
    buffer_load_dwordx4 v4, s[36:39], s64 offen offset:3072 lds
    v_mul_u32_u24_e64 v15, s79, v54
    v_mov_b32 v53, 4064
    s_add_u32 m0, s66, 102400
    s_nop 0
    buffer_load_dwordx4 v5, s[36:39], s64 offen offset:0 lds
    v_lshlrev_b32 v53, v50, v53
    v_lshrrev_b32_e64 v53, v52, v53
    buffer_load_dwordx4 v6, s[36:39], s64 offen offset:1024 lds
    v_bfe_u32 v54, v53, 0, 1
    v_bfe_u32 v55, v53, 1, 1
    buffer_load_dwordx4 v7, s[36:39], s64 offen offset:2048 lds
    v_lshl_or_b32 v54, v55, 16, v54
    buffer_load_dwordx4 v8, s[36:39], s64 offen offset:3072 lds
    s_add_u32 s64, s64, s65
    s_cmp_eq_u32 s56, 2
    s_cselect_b32 s90, s67, 0
    s_sub_u32 s64, s64, s90
    s_barrier
    v_mul_u32_u24 v60, s79, v54
    v_bfe_u32 v54, v53, 2, 1
    s_add_u32 m0, s66, 131072
    s_nop 0
    buffer_load_dwordx4 v1, s[36:39], s64 offen offset:0 lds
    v_bfe_u32 v55, v53, 3, 1
    v_lshl_or_b32 v54, v55, 16, v54
    buffer_load_dwordx4 v2, s[36:39], s64 offen offset:1024 lds
    v_mul_u32_u24 v61, s79, v54
    buffer_load_dwordx4 v3, s[36:39], s64 offen offset:2048 lds
    v_bfe_u32 v54, v53, 4, 1
    v_bfe_u32 v55, v53, 5, 1
    buffer_load_dwordx4 v4, s[36:39], s64 offen offset:3072 lds
    v_lshl_or_b32 v54, v55, 16, v54
    s_add_u32 m0, s66, 135168
    s_nop 0
    buffer_load_dwordx4 v5, s[36:39], s64 offen offset:0 lds
    v_mul_u32_u24 v62, s79, v54
    v_bfe_u32 v54, v53, 6, 1
    buffer_load_dwordx4 v6, s[36:39], s64 offen offset:1024 lds
    v_bfe_u32 v55, v53, 7, 1
    buffer_load_dwordx4 v7, s[36:39], s64 offen offset:2048 lds
    v_lshl_or_b32 v54, v55, 16, v54
    v_mul_u32_u24_e64 v63, s79, v54
    buffer_load_dwordx4 v8, s[36:39], s64 offen offset:3072 lds
    s_add_u32 s64, s64, s65
    s_cmp_eq_u32 s56, 1
    s_cselect_b32 s90, s67, 0
    s_sub_u32 s64, s64, s90
    s_mul_i32 s79, s68, 768
    s_lshl_b32 s90, s68, 11
    s_add_u32 s90, s90, L_gtab-L_pc
    buffer_load_dwordx4 v[120:123], v9, s[48:51], s90 offen offset:0
    buffer_load_dwordx4 v[124:127], v9, s[48:51], s90 offen offset:1024
    s_barrier
    s_sub_u32 s79, 1200, s79
    v_add_u32 v11, s79, v36
    s_add_u32 m0, s66, 32768
    s_nop 0
    buffer_load_dwordx4 v1, s[36:39], s64 offen offset:0 lds
    s_mul_i32 s79, s69, 9472
    s_add_u32 s78, s79, 9532
    buffer_load_dwordx4 v2, s[36:39], s64 offen offset:1024 lds
    v_lshlrev_b32 v53, 2, v51
    v_sub_u32 v53, v53, v50
    buffer_load_dwordx4 v3, s[36:39], s64 offen offset:2048 lds
    v_lshl_add_u32 v10, v53, 2, s78
    s_add_u32 s79, s79, 512
    buffer_load_dwordx4 v4, s[36:39], s64 offen offset:3072 lds
    v_and_b32_e64 v53, 3, v0
    v_mul_u32_u24 v53, 2240, v53
    s_add_u32 m0, s66, 36864
    s_nop 0
    buffer_load_dwordx4 v5, s[36:39], s64 offen offset:0 lds
    v_lshrrev_b32 v54, 2, v0
    v_lshl_add_u32 v53, v54, 4, v53
    buffer_load_dwordx4 v6, s[36:39], s64 offen offset:1024 lds
    v_lshl_add_u32 v53, v51, 11, v53
    v_lshlrev_b32_e64 v54, 2, v0
    buffer_load_dwordx4 v7, s[36:39], s64 offen offset:2048 lds
    v_add_u32 v54, 8960, v54
    buffer_load_dwordx4 v8, s[36:39], s64 offen offset:3072 lds
    s_waitcnt vmcnt(18)
    s_barrier
    s_cmp_eq_u32 s68, 0
    s_cselect_b64 vcc, -1, 0
    s_cselect_b32 s72, s72, 0
    v_cndmask_b32 v53, v53, v54, vcc
    s_add_u32 m0, s91, 0
    s_nop 0
    buffer_load_dwordx4 v48, s[40:43], s88 offen lds
    v_add_u32_e64 v34, s79, v53
    s_mul_i32 s79, s69, 6144
    buffer_load_dwordx4 v49, s[40:43], s88 offen offset:1024 lds
    s_add_u32 s88, s88, 14336
    s_add_u32 s79, s79, 33792
    v_mov_b32 v50, s72
    s_add_u32 m0, s91, 2048
    s_nop 0
    buffer_load_dwordx4 v48, s[40:43], s88 offen lds
    v_cmp_eq_u32 vcc, 0, v0
    buffer_load_dwordx4 v49, s[40:43], s88 offen offset:1024 lds
    s_add_u32 s88, s88, 14336
    v_mov_b32 v51, s79
    v_mov_b32 v245, 0
    s_add_u32 m0, s91, 4096
    s_nop 0
    buffer_load_dwordx4 v48, s[40:43], s88 offen lds
    v_cndmask_b32 v244, 0, v50, vcc
    v_mov_b32 v246, 0
    buffer_load_dwordx4 v49, s[40:43], s88 offen offset:1024 lds
    s_add_u32 s88, s88, 14336
    v_mov_b32 v247, 0
    v_cmp_gt_u32 vcc, 48, v0
    s_add_u32 m0, s91, 6144
    s_nop 0
    buffer_load_dwordx4 v48, s[40:43], s88 offen lds
    s_waitcnt vmcnt(16)
    v_add_u32_sdwa v16, v51, v120 dst_sel:DWORD dst_unused:UNUSED_PAD src0_sel:DWORD src1_sel:WORD_0
    buffer_load_dwordx4 v49, s[40:43], s88 offen offset:1024 lds
    s_add_u32 s88, s88, 14336
    s_barrier
    v_add_u32_sdwa v17, v51, v120 dst_sel:DWORD dst_unused:UNUSED_PAD src0_sel:DWORD src1_sel:WORD_1
    v_add_u32_sdwa v18, v51, v121 dst_sel:DWORD dst_unused:UNUSED_PAD src0_sel:DWORD src1_sel:WORD_0
    s_add_u32 m0, s91, 32768
    s_nop 0
    buffer_load_dwordx4 v48, s[40:43], s88 offen lds
    v_add_u32_sdwa v19, v51, v121 dst_sel:DWORD dst_unused:UNUSED_PAD src0_sel:DWORD src1_sel:WORD_1
    v_add_u32_sdwa v20, v51, v122 dst_sel:DWORD dst_unused:UNUSED_PAD src0_sel:DWORD src1_sel:WORD_0
    buffer_load_dwordx4 v49, s[40:43], s88 offen offset:1024 lds
    s_add_u32 s88, s88, 14336
    v_add_u32_sdwa v21, v51, v122 dst_sel:DWORD dst_unused:UNUSED_PAD src0_sel:DWORD src1_sel:WORD_1
    v_add_u32_sdwa v22, v51, v123 dst_sel:DWORD dst_unused:UNUSED_PAD src0_sel:DWORD src1_sel:WORD_0
    s_add_u32 m0, s91, 34816
    s_nop 0
    buffer_load_dwordx4 v48, s[40:43], s88 offen lds
    v_add_u32_sdwa v23, v51, v123 dst_sel:DWORD dst_unused:UNUSED_PAD src0_sel:DWORD src1_sel:WORD_1
    s_waitcnt vmcnt(19)
    v_add_u32_sdwa v24, v51, v124 dst_sel:DWORD dst_unused:UNUSED_PAD src0_sel:DWORD src1_sel:WORD_0
    buffer_load_dwordx4 v49, s[40:43], s88 offen offset:1024 lds
    s_add_u32 s88, s88, 14336
    v_add_u32_sdwa v25, v51, v124 dst_sel:DWORD dst_unused:UNUSED_PAD src0_sel:DWORD src1_sel:WORD_1
    v_add_u32_sdwa v26, v51, v125 dst_sel:DWORD dst_unused:UNUSED_PAD src0_sel:DWORD src1_sel:WORD_0
    s_add_u32 m0, s91, 36864
    s_nop 0
    buffer_load_dwordx4 v48, s[40:43], s88 offen lds
    v_add_u32_sdwa v27, v51, v125 dst_sel:DWORD dst_unused:UNUSED_PAD src0_sel:DWORD src1_sel:WORD_1
    v_add_u32_sdwa v28, v51, v126 dst_sel:DWORD dst_unused:UNUSED_PAD src0_sel:DWORD src1_sel:WORD_0
    buffer_load_dwordx4 v49, s[40:43], s88 offen offset:1024 lds
    s_add_u32 s88, s88, 14336
    v_add_u32_sdwa v29, v51, v126 dst_sel:DWORD dst_unused:UNUSED_PAD src0_sel:DWORD src1_sel:WORD_1
    v_add_u32_sdwa v30, v51, v127 dst_sel:DWORD dst_unused:UNUSED_PAD src0_sel:DWORD src1_sel:WORD_0
    s_add_u32 m0, s91, 38912
    s_nop 0
    buffer_load_dwordx4 v48, s[40:43], s88 offen lds
    v_add_u32_sdwa v31, v51, v127 dst_sel:DWORD dst_unused:UNUSED_PAD src0_sel:DWORD src1_sel:WORD_1
    buffer_load_dwordx4 v49, s[40:43], s88 offen offset:1024 lds
    s_add_u32 s88, s88, 14336
    s_waitcnt vmcnt(16)
    s_waitcnt vmcnt(8)
    s_barrier
    s_add_u32 m0, s91, 65536
    s_nop 0
    buffer_load_dwordx4 v48, s[40:43], s88 offen lds
    buffer_load_dwordx4 v49, s[40:43], s88 offen offset:1024 lds
    s_add_u32 s88, s88, 14336
    s_add_u32 m0, s91, 67584
    s_nop 0
    buffer_load_dwordx4 v48, s[40:43], s88 offen lds
    buffer_load_dwordx4 v49, s[40:43], s88 offen offset:1024 lds
    s_add_u32 s88, s88, 14336
    s_add_u32 m0, s91, 69632
    s_nop 0
    buffer_load_dwordx4 v48, s[40:43], s88 offen lds
    buffer_load_dwordx4 v49, s[40:43], s88 offen offset:1024 lds
    s_add_u32 s88, s88, 14336
    s_add_u32 m0, s91, 71680
    s_nop 0
    buffer_load_dwordx4 v48, s[40:43], s88 offen lds
    buffer_load_dwordx4 v49, s[40:43], s88 offen offset:1024 lds
    s_add_u32 s88, s88, 14336
    s_barrier
    s_mul_i32 m0, s70, 8448
    s_setprio 1
    ds_write_addtid_b32 v224 offset:0
    ds_write_addtid_b32 v225 offset:256
    ds_write_addtid_b32 v226 offset:528
    ds_write_addtid_b32 v227 offset:784
    ds_write_addtid_b32 v228 offset:1056
    ds_write_addtid_b32 v229 offset:1312
    ds_write_addtid_b32 v230 offset:1584
    ds_write_addtid_b32 v231 offset:1840
    ds_write_addtid_b32 v232 offset:2112
    ds_write_addtid_b32 v233 offset:2368
    ds_write_addtid_b32 v234 offset:2640
    ds_write_addtid_b32 v235 offset:2896
    ds_write_addtid_b32 v236 offset:3168
    ds_write_addtid_b32 v237 offset:3424
    ds_write_addtid_b32 v238 offset:3696
    ds_write_addtid_b32 v239 offset:3952
    ds_write_addtid_b32 v240 offset:4224
    ds_write_addtid_b32 v241 offset:4480
    ds_read_b128 v[64:67], v47 offset:0
    ds_read_b128 v[68:71], v47 offset:32
    ds_read_b128 v[72:75], v47 offset:64
    ds_read_b128 v[76:79], v47 offset:96
    ds_read_b128 v[80:83], v47 offset:128
    ds_read_b128 v[84:87], v47 offset:160
    ds_read_b128 v[88:91], v47 offset:192
    ds_read_b128 v[92:95], v47 offset:224
    s_buffer_load_dwordx8 s[80:87], s[44:47], s74 glc
    ds_write_addtid_b32 v128 offset:0
    ds_write_addtid_b32 v129 offset:256
    ds_write_addtid_b32 v130 offset:528
    ds_write_addtid_b32 v131 offset:784
    ds_write_addtid_b32 v132 offset:1056
    ds_write_addtid_b32 v133 offset:1312
    ds_write_addtid_b32 v134 offset:1584
    ds_write_addtid_b32 v135 offset:1840
    ds_write_addtid_b32 v136 offset:2112
    ds_write_addtid_b32 v137 offset:2368
    ds_write_addtid_b32 v138 offset:2640
    ds_write_addtid_b32 v139 offset:2896
    ds_write_addtid_b32 v140 offset:3168
    ds_write_addtid_b32 v141 offset:3424
    ds_write_addtid_b32 v142 offset:3696
    ds_write_addtid_b32 v143 offset:3952
    ds_write_addtid_b32 v144 offset:4224
    ds_write_addtid_b32 v145 offset:4480
    ds_write_addtid_b32 v146 offset:4752
    ds_write_addtid_b32 v147 offset:5008
    ds_write_addtid_b32 v148 offset:5280
    ds_write_addtid_b32 v149 offset:5536
    ds_write_addtid_b32 v150 offset:5808
    ds_write_addtid_b32 v151 offset:6064
    ds_write_addtid_b32 v152 offset:6336
    ds_write_addtid_b32 v153 offset:6592
    ds_write_addtid_b32 v154 offset:6864
    ds_write_addtid_b32 v155 offset:7120
    ds_write_addtid_b32 v156 offset:7392
    ds_write_addtid_b32 v157 offset:7648
    ds_write_addtid_b32 v158 offset:7920
    ds_write_addtid_b32 v159 offset:8176
    ds_read_b128 v[128:131], v47 offset:0
    ds_read_b128 v[132:135], v47 offset:32
    ds_read_b128 v[136:139], v47 offset:64
    ds_read_b128 v[140:143], v47 offset:96
    ds_read_b128 v[144:147], v47 offset:128
    ds_read_b128 v[148:151], v47 offset:160
    ds_read_b128 v[152:155], v47 offset:192
    ds_read_b128 v[156:159], v47 offset:224
    ds_write_addtid_b32 v192 offset:0
    ds_write_addtid_b32 v193 offset:256
    ds_write_addtid_b32 v194 offset:528
    ds_write_addtid_b32 v195 offset:784
    ds_write_addtid_b32 v196 offset:1056
    ds_write_addtid_b32 v197 offset:1312
    ds_write_addtid_b32 v198 offset:1584
    ds_write_addtid_b32 v199 offset:1840
    s_mov_b32 s96, 0
L_chk_1:
    s_waitcnt lgkmcnt(0)
    s_cmp_eq_u64 s[80:81], s[52:53]
    s_cbranch_scc0 L_retry_2
    s_cmp_eq_u64 s[82:83], s[52:53]
    s_cbranch_scc0 L_retry_2
    s_cmp_eq_u64 s[84:85], s[52:53]
    s_cbranch_scc0 L_retry_2
    s_cmp_eq_u64 s[86:87], s[52:53]
    s_cbranch_scc1 L_chkd_3
L_retry_2:
    s_buffer_load_dwordx8 s[80:87], s[44:47], s74 glc
    s_add_u32 s96, s96, 1
    s_cmp_le_u32 s96, 131072
    s_cbranch_scc1 L_chk_1
    s_waitcnt lgkmcnt(0)
L_chkd_3:
    s_waitcnt vmcnt(0)
    s_mov_b64 exec, 1
    ds_write_b32 v39, v42 offset:64
    s_mov_b64 exec, -1
    buffer_load_dwordx4 v[2:5], v9, s[44:47], s75 offen sc1
    s_add_u32 s75, s75, 4608
    buffer_load_dwordx4 v[52:55], v9, s[44:47], s75 offen sc1
    ds_write_addtid_b32 v200 offset:2112
    ds_write_addtid_b32 v201 offset:2368
    v_mfma_f32_16x16x32_bf16 v[252:255], v[64:67], v[128:131], 0
    ds_write_addtid_b32 v202 offset:2640
    ds_write_addtid_b32 v203 offset:2896
    v_mfma_f32_16x16x32_bf16 v[252:255], v[68:71], v[132:135], v[252:255]
    ds_write_addtid_b32 v204 offset:3168
    ds_write_addtid_b32 v205 offset:3424
    v_mfma_f32_16x16x32_bf16 v[252:255], v[72:75], v[136:139], v[252:255]
    ds_write_addtid_b32 v206 offset:3696
    ds_write_addtid_b32 v207 offset:3952
    v_mfma_f32_16x16x32_bf16 v[252:255], v[76:79], v[140:143], v[252:255]
    ds_write_addtid_b32 v208 offset:4224
    ds_write_addtid_b32 v209 offset:4480
    v_mfma_f32_16x16x32_bf16 v[252:255], v[80:83], v[144:147], v[252:255]
    ds_write_addtid_b32 v210 offset:4752
    ds_write_addtid_b32 v211 offset:5008
    v_mfma_f32_16x16x32_bf16 v[252:255], v[84:87], v[148:151], v[252:255]
    ds_write_addtid_b32 v212 offset:5280
    ds_write_addtid_b32 v213 offset:5536
    v_mfma_f32_16x16x32_bf16 v[252:255], v[88:91], v[152:155], v[252:255]
    ds_write_addtid_b32 v214 offset:5808
    ds_write_addtid_b32 v215 offset:6064
    v_mfma_f32_16x16x32_bf16 v[252:255], v[92:95], v[156:159], v[252:255]
    ds_write_addtid_b32 v216 offset:6336
    ds_write_addtid_b32 v217 offset:6592
    ds_write_addtid_b32 v218 offset:6864
    ds_write_addtid_b32 v219 offset:7120
    ds_write_addtid_b32 v220 offset:7392
    ds_write_addtid_b32 v221 offset:7648
    s_nop 1
    v_cndmask_b32 v252, 0, v252, vcc
    ds_write_b128 v32, v[252:255] offset:2048
    ds_write_addtid_b32 v222 offset:7920
    ds_write_addtid_b32 v223 offset:8176
    ds_read_b128 v[192:195], v47 offset:0
    ds_read_b128 v[196:199], v47 offset:32
    ds_read_b128 v[200:203], v47 offset:64
    ds_read_b128 v[204:207], v47 offset:96
    ds_read_b128 v[208:211], v47 offset:128
    ds_read_b128 v[212:215], v47 offset:160
    ds_read_b128 v[216:219], v47 offset:192
    ds_read_b128 v[220:223], v47 offset:224
    ds_write_addtid_b32 v160 offset:0
    ds_write_addtid_b32 v161 offset:256
    ds_write_addtid_b32 v162 offset:528
    ds_write_addtid_b32 v163 offset:784
    ds_write_addtid_b32 v164 offset:1056
    ds_write_addtid_b32 v165 offset:1312
    ds_write_addtid_b32 v166 offset:1584
    ds_write_addtid_b32 v167 offset:1840
    ds_write_addtid_b32 v168 offset:2112
    ds_write_addtid_b32 v169 offset:2368
    s_waitcnt lgkmcnt(14)
    v_mfma_f32_16x16x32_bf16 v[248:251], v[192:195], v[128:131], 0
    ds_write_addtid_b32 v170 offset:2640
    ds_write_addtid_b32 v171 offset:2896
    v_mfma_f32_16x16x32_bf16 v[248:251], v[196:199], v[132:135], v[248:251]
    ds_write_addtid_b32 v172 offset:3168
    ds_write_addtid_b32 v173 offset:3424
    v_mfma_f32_16x16x32_bf16 v[248:251], v[200:203], v[136:139], v[248:251]
    ds_write_addtid_b32 v174 offset:3696
    ds_write_addtid_b32 v175 offset:3952
    v_mfma_f32_16x16x32_bf16 v[248:251], v[204:207], v[140:143], v[248:251]
    ds_write_addtid_b32 v176 offset:4224
    ds_write_addtid_b32 v177 offset:4480
    s_waitcnt lgkmcnt(14)
    v_mfma_f32_16x16x32_bf16 v[248:251], v[208:211], v[144:147], v[248:251]
    ds_write_addtid_b32 v178 offset:4752
    ds_write_addtid_b32 v179 offset:5008
    v_mfma_f32_16x16x32_bf16 v[248:251], v[212:215], v[148:151], v[248:251]
    ds_write_addtid_b32 v180 offset:5280
    ds_write_addtid_b32 v181 offset:5536
    v_mfma_f32_16x16x32_bf16 v[248:251], v[216:219], v[152:155], v[248:251]
    ds_write_addtid_b32 v182 offset:5808
    ds_write_addtid_b32 v183 offset:6064
    v_mfma_f32_16x16x32_bf16 v[248:251], v[220:223], v[156:159], v[248:251]
    ds_write_addtid_b32 v184 offset:6336
    ds_write_addtid_b32 v185 offset:6592
    ds_write_addtid_b32 v186 offset:6864
    ds_write_addtid_b32 v187 offset:7120
    ds_write_addtid_b32 v188 offset:7392
    ds_write_addtid_b32 v189 offset:7648
    s_nop 1
    ds_write_b128 v32, v[248:251] offset:1024
    ds_write_addtid_b32 v190 offset:7920
    ds_write_addtid_b32 v191 offset:8176
    ds_read_b128 v[160:163], v47 offset:0
    ds_read_b128 v[164:167], v47 offset:32
    ds_read_b128 v[168:171], v47 offset:64
    ds_read_b128 v[172:175], v47 offset:96
    ds_read_b128 v[176:179], v47 offset:128
    ds_read_b128 v[180:183], v47 offset:160
    ds_read_b128 v[184:187], v47 offset:192
    ds_read_b128 v[188:191], v47 offset:224
    s_waitcnt lgkmcnt(7)
    v_mfma_f32_16x16x32_bf16 v[244:247], v[160:163], v[128:131], v[244:247]
    s_waitcnt lgkmcnt(6)
    v_mfma_f32_16x16x32_bf16 v[244:247], v[164:167], v[132:135], v[244:247]
    s_waitcnt lgkmcnt(5)
    v_mfma_f32_16x16x32_bf16 v[244:247], v[168:171], v[136:139], v[244:247]
    s_waitcnt lgkmcnt(4)
    v_mfma_f32_16x16x32_bf16 v[244:247], v[172:175], v[140:143], v[244:247]
    s_waitcnt lgkmcnt(3)
    v_mfma_f32_16x16x32_bf16 v[244:247], v[176:179], v[144:147], v[244:247]
    s_waitcnt lgkmcnt(2)
    v_mfma_f32_16x16x32_bf16 v[244:247], v[180:183], v[148:151], v[244:247]
    s_waitcnt lgkmcnt(1)
    v_mfma_f32_16x16x32_bf16 v[244:247], v[184:187], v[152:155], v[244:247]
    s_waitcnt lgkmcnt(0)
    v_mfma_f32_16x16x32_bf16 v[244:247], v[188:191], v[156:159], v[244:247]
    s_nop 7
    ds_write_b128 v32, v[244:247]
    s_mov_b64 exec, 1
    ds_write_b32 v39, v42 offset:0
    s_mov_b64 exec, -1
    s_mov_b32 s96, 0
L_spin_4:
    ds_read_b32 v50, v38 offset:0
    s_add_u32 s96, s96, 1
    s_cmp_gt_u32 s96, 1048576
    s_waitcnt lgkmcnt(0)
    v_cmp_ne_u32 vcc, s52, v50
    s_cbranch_scc1 L_spun_5
    s_nop 3
    s_cbranch_vccnz L_spin_4
L_spun_5:
    ds_read2st64_b32 v[96:97], v16 offset0:0 offset1:12
    ds_read2st64_b32 v[98:99], v17 offset0:0 offset1:12
    ds_read2st64_b32 v[100:101], v18 offset0:0 offset1:12
    ds_read2st64_b32 v[102:103], v19 offset0:0 offset1:12
    ds_read2st64_b32 v[104:105], v20 offset0:0 offset1:12
    ds_read2st64_b32 v[106:107], v21 offset0:0 offset1:12
    ds_read2st64_b32 v[108:109], v22 offset0:0 offset1:12
    ds_read2st64_b32 v[110:111], v23 offset0:0 offset1:12
    ds_read2st64_b32 v[112:113], v24 offset0:0 offset1:12
    ds_read2st64_b32 v[114:115], v25 offset0:0 offset1:12
    ds_read2st64_b32 v[116:117], v26 offset0:0 offset1:12
    ds_read2st64_b32 v[118:119], v27 offset0:0 offset1:12
    ds_read2st64_b32 v[120:121], v28 offset0:0 offset1:12
    ds_read2st64_b32 v[122:123], v29 offset0:0 offset1:12
    ds_read2st64_b32 v[124:125], v30 offset0:0 offset1:12
    ds_read2st64_b32 v[126:127], v31 offset0:0 offset1:12
    s_waitcnt vmcnt(1)
    ds_write_b128 v37, v[2:5] offset:0
L_hop1:
    s_cbranch_execz L_hopped
    s_waitcnt vmcnt(0)
    s_nop 0
    ds_write_b128 v37, v[52:55] offset:4608
    ds_write_b32 v43, v56
    s_waitcnt lgkmcnt(14)
    v_add_f32 v96, v96, v97
    v_add_f32 v98, v98, v99
    v_add_f32 v100, v100, v101
    v_add_f32 v102, v102, v103
    v_add_f32 v104, v104, v105
    s_waitcnt lgkmcnt(13)
    v_add_f32 v106, v106, v107
    s_waitcnt lgkmcnt(12)
    v_add_f32 v108, v108, v109
    s_waitcnt lgkmcnt(11)
    v_add_f32 v110, v110, v111
    s_waitcnt lgkmcnt(10)
    v_add_f32 v112, v112, v113
    s_waitcnt lgkmcnt(9)
    v_add_f32 v114, v114, v115
    s_waitcnt lgkmcnt(8)
    v_add_f32 v116, v116, v117
    v_cvt_pk_bf16_f32 v128, v96, v98
    v_cvt_pk_bf16_f32 v129, v100, v102
    v_cvt_pk_bf16_f32 v130, v104, v106
    v_cvt_pk_bf16_f32 v131, v108, v110
    ds_write_b128 v33, v[128:131] offset:64
    v_cvt_pk_bf16_f32 v132, v98, v100
    v_cvt_pk_bf16_f32 v133, v102, v104
    v_cvt_pk_bf16_f32 v134, v106, v108
    v_cvt_pk_bf16_f32 v135, v110, v112
    ds_write_b128 v33, v[132:135] offset:2304
    v_cvt_pk_bf16_f32 v136, v100, v102
    v_cvt_pk_bf16_f32 v137, v104, v106
    v_cvt_pk_bf16_f32 v138, v108, v110
    v_cvt_pk_bf16_f32 v139, v112, v114
    ds_write_b128 v33, v[136:139] offset:4544
    v_cvt_pk_bf16_f32 v140, v102, v104
    v_cvt_pk_bf16_f32 v141, v106, v108
    v_cvt_pk_bf16_f32 v142, v110, v112
    v_cvt_pk_bf16_f32 v143, v114, v116
    ds_write_b128 v33, v[140:143] offset:6784
    s_waitcnt lgkmcnt(11)
    v_add_f32 v118, v118, v119
    s_waitcnt lgkmcnt(10)
    v_add_f32 v120, v120, v121
    s_waitcnt lgkmcnt(9)
    v_add_f32 v122, v122, v123
    s_waitcnt lgkmcnt(8)
    v_add_f32 v124, v124, v125
    s_waitcnt lgkmcnt(7)
    v_add_f32 v126, v126, v127
    v_cvt_pk_bf16_f32 v144, v118, v120
    s_cmp_lg_u32 s68, 0
    s_cbranch_scc1 L_edge_6
    ds_write_b32 v34, v144
    s_mov_b64 exec, 0xffff
    ds_write_b32 v34, v56 offset:256
    s_branch L_tabd_7
L_edge_6:
    v_cvt_pk_bf16_f32 v145, v122, v124
    v_cvt_pk_bf16_f32 v146, v124, v124
    v_cvt_pk_bf16_f32 v147, v124, v126
    s_mov_b64 exec, 0xffffff
    ds_write_b128 v34, v[144:147]
L_tabd_7:
    s_mov_b64 exec, -1
    s_mov_b64 exec, 1
    ds_write_b32 v39, v42 offset:16
    s_mov_b64 exec, -1
    s_mov_b32 s96, 0
L_spin_8:
    ds_read_b32 v50, v38 offset:16
    s_add_u32 s96, s96, 1
    s_cmp_gt_u32 s96, 1048576
    s_waitcnt lgkmcnt(0)
    v_cmp_ne_u32 vcc, s52, v50
    s_cbranch_scc1 L_spun_9
    s_nop 3
    s_cbranch_vccnz L_spin_8
L_spun_9:
    ds_read_b128 v[160:163], v36 offset:192
    ds_read_b64 v[96:97], v35 offset:2048
    ds_read_b64 v[98:99], v35 offset:2056
    ds_read_b64 v[100:101], v35 offset:1536
    ds_read_b64 v[102:103], v35 offset:1544
    ds_read_b128 v[164:167], v36 offset:704
    ds_read_b64 v[104:105], v35 offset:1024
    ds_read_b64 v[106:107], v35 offset:1032
    ds_read_b128 v[168:171], v36 offset:1216
    ds_read_b64 v[108:109], v35 offset:512
    ds_read_b64 v[110:111], v35 offset:520
    s_waitcnt lgkmcnt(8)
    v_mfma_f32_16x16x32_bf16 v[224:227], v[160:163], v[96:99], 0
    ds_read_b128 v[172:175], v36 offset:1728
    s_waitcnt lgkmcnt(7)
    v_mfma_f32_16x16x32_bf16 v[228:231], v[160:163], v[100:103], 0
    ds_read_b128 v[176:179], v36 offset:2240
    s_waitcnt lgkmcnt(7)
    v_mfma_f32_16x16x32_bf16 v[228:231], v[164:167], v[96:99], v[228:231]
    ds_read_b128 v[128:131], v11 offset:0
    s_waitcnt lgkmcnt(6)
    v_mfma_f32_16x16x32_bf16 v[232:235], v[160:163], v[104:107], 0
    ds_read_b128 v[132:135], v11 offset:16
    v_mfma_f32_16x16x32_bf16 v[232:235], v[164:167], v[100:103], v[232:235]
    ds_read_b128 v[136:139], v11 offset:512
    s_waitcnt lgkmcnt(7)
    v_mfma_f32_16x16x32_bf16 v[232:235], v[168:171], v[96:99], v[232:235]
    ds_read_b128 v[140:143], v11 offset:528
    ds_read_b128 v[180:183], v36 offset:2752
    s_waitcnt lgkmcnt(7)
    v_mfma_f32_16x16x32_bf16 v[236:239], v[160:163], v[108:111], 0
    ds_read_b128 v[184:187], v36 offset:3264
    v_mfma_f32_16x16x32_bf16 v[236:239], v[164:167], v[104:107], v[236:239]
    ds_read_b128 v[188:191], v36 offset:3776
    v_mfma_f32_16x16x32_bf16 v[236:239], v[168:171], v[100:103], v[236:239]
    ds_read2_b32 v[72:73], v10 offset0:48 offset1:49
    s_waitcnt lgkmcnt(9)
    v_mfma_f32_16x16x32_bf16 v[236:239], v[172:175], v[96:99], v[236:239]
    ds_read2_b32 v[74:75], v10 offset0:50 offset1:51
    v_mfma_f32_16x16x32_bf16 v[240:243], v[164:167], v[108:111], 0
    ds_read2_b32 v[76:77], v10 offset0:32 offset1:33
    v_mfma_f32_16x16x32_bf16 v[240:243], v[168:171], v[104:107], v[240:243]
    ds_read2_b32 v[78:79], v10 offset0:34 offset1:35
    ds_read2_b32 v[80:81], v10 offset0:16 offset1:17
    s_waitcnt lgkmcnt(11)
    v_mfma_f32_16x16x32_bf16 v[144:147], v[128:131], v[12:15], 0
    ds_read2_b32 v[82:83], v10 offset0:18 offset1:19
    s_waitcnt lgkmcnt(11)
    v_mfma_f32_16x16x32_bf16 v[148:151], v[132:135], v[60:63], 0
    ds_read2_b32 v[84:85], v10 offset0:0 offset1:1
    s_waitcnt lgkmcnt(11)
    v_mfma_f32_16x16x32_bf16 v[152:155], v[136:139], v[12:15], 0
    ds_read2_b32 v[86:87], v10 offset0:2 offset1:3
    s_waitcnt lgkmcnt(11)
    v_mfma_f32_16x16x32_bf16 v[156:159], v[140:143], v[60:63], 0
    ds_read_b64 v[88:89], v35 offset:0
    ds_read_b64 v[90:91], v35 offset:8
    v_mfma_f32_16x16x32_bf16 v[240:243], v[172:175], v[100:103], v[240:243]
    ds_read_b128 v[192:195], v36 offset:128
    v_mfma_f32_16x16x32_bf16 v[240:243], v[176:179], v[96:99], v[240:243]
    ds_read_b64 v[112:113], v35 offset:1984
    v_mfma_f32_16x16x32_bf16 v[244:247], v[168:171], v[108:111], 0
    ds_read_b64 v[114:115], v35 offset:1992
    ds_read_b64 v[116:117], v35 offset:1472
    v_mfma_f32_16x16x32_bf16 v[244:247], v[172:175], v[104:107], v[244:247]
    ds_read_b64 v[118:119], v35 offset:1480
    v_mfma_f32_16x16x32_bf16 v[244:247], v[176:179], v[100:103], v[244:247]
    ds_read_b128 v[196:199], v36 offset:640
    s_waitcnt lgkmcnt(14)
    s_nop 0
    v_mfma_f32_16x16x32_bf16 v[244:247], v[180:183], v[96:99], v[244:247]
    ds_read_b64 v[120:121], v35 offset:960
    ds_read_b64 v[122:123], v35 offset:968
    v_mfma_f32_16x16x32_bf16 v[248:251], v[172:175], v[108:111], 0
    v_cvt_pk_bf16_f32 v64, v144, v148
    ds_read_b128 v[200:203], v36 offset:1152
    v_mfma_f32_16x16x32_bf16 v[248:251], v[176:179], v[104:107], v[248:251]
    v_cvt_pk_bf16_f32 v65, v145, v149
    ds_read_b64 v[124:125], v35 offset:448
    v_mfma_f32_16x16x32_bf16 v[248:251], v[180:183], v[100:103], v[248:251]
    v_cvt_pk_bf16_f32 v66, v146, v150
    ds_read_b64 v[126:127], v35 offset:456
    v_mfma_f32_16x16x32_bf16 v[248:251], v[184:187], v[96:99], v[248:251]
    v_cvt_pk_bf16_f32 v67, v147, v151
    ds_read_b128 v[204:207], v36 offset:1664
    v_mfma_f32_16x16x32_bf16 v[252:255], v[176:179], v[108:111], 0
    v_cvt_pk_bf16_f32 v68, v152, v156
    ds_read_b128 v[208:211], v36 offset:2176
    v_mfma_f32_16x16x32_bf16 v[252:255], v[180:183], v[104:107], v[252:255]
    v_cvt_pk_bf16_f32 v69, v153, v157
    ds_read_b128 v[212:215], v36 offset:2688
    v_mfma_f32_16x16x32_bf16 v[252:255], v[184:187], v[100:103], v[252:255]
    v_cvt_pk_bf16_f32 v70, v154, v158
    ds_read_b128 v[216:219], v36 offset:3200
    v_mfma_f32_16x16x32_bf16 v[252:255], v[188:191], v[96:99], v[252:255]
    v_cvt_pk_bf16_f32 v71, v155, v159
    ds_read_b128 v[220:223], v36 offset:3712
    s_cmp_lg_u32 s68, 0
    s_cbranch_scc1 L_far1_10
    s_waitcnt lgkmcnt(14)
    v_mfma_f32_16x16x32_bf16 v[240:243], v[160:163], v[88:91], v[240:243]
    v_mfma_f32_16x16x32_bf16 v[244:247], v[164:167], v[88:91], v[244:247]
    v_mfma_f32_16x16x32_bf16 v[248:251], v[168:171], v[88:91], v[248:251]
    v_mfma_f32_16x16x32_bf16 v[252:255], v[172:175], v[88:91], v[252:255]
    v_mfma_f32_16x16x32_bf16 v[248:251], v[72:75], v[64:67], v[248:251]
    v_mfma_f32_16x16x32_bf16 v[252:255], v[76:79], v[64:67], v[252:255]
    v_mfma_f32_16x16x32_bf16 v[252:255], v[72:75], v[68:71], v[252:255]
    s_branch L_fard_11
L_far1_10:
    v_mfma_f32_16x16x32_bf16 v[240:243], v[72:75], v[64:67], v[240:243]
    s_waitcnt lgkmcnt(14)
    v_mfma_f32_16x16x32_bf16 v[244:247], v[76:79], v[64:67], v[244:247]
    v_mfma_f32_16x16x32_bf16 v[248:251], v[80:83], v[64:67], v[248:251]
    v_mfma_f32_16x16x32_bf16 v[252:255], v[84:87], v[64:67], v[252:255]
    v_mfma_f32_16x16x32_bf16 v[244:247], v[72:75], v[68:71], v[244:247]
    v_mfma_f32_16x16x32_bf16 v[248:251], v[76:79], v[68:71], v[248:251]
    v_mfma_f32_16x16x32_bf16 v[252:255], v[80:83], v[68:71], v[252:255]
L_fard_11:
    s_waitcnt lgkmcnt(13)
    v_mfma_f32_16x16x32_bf16 v[224:227], v[192:195], v[112:115], v[224:227]
    s_waitcnt lgkmcnt(11)
    v_mfma_f32_16x16x32_bf16 v[228:231], v[192:195], v[116:119], v[228:231]
    ds_read_b128 v[160:163], v36 offset:64
    s_waitcnt lgkmcnt(11)
    v_mfma_f32_16x16x32_bf16 v[228:231], v[196:199], v[112:115], v[228:231]
    ds_read_b64 v[96:97], v35 offset:1920
    s_waitcnt lgkmcnt(10)
    v_mfma_f32_16x16x32_bf16 v[232:235], v[192:195], v[120:123], v[232:235]
    ds_read_b64 v[98:99], v35 offset:1928
    v_mfma_f32_16x16x32_bf16 v[232:235], v[196:199], v[116:119], v[232:235]
    ds_read_b64 v[100:101], v35 offset:1408
    s_waitcnt lgkmcnt(11)
    v_mfma_f32_16x16x32_bf16 v[232:235], v[200:203], v[112:115], v[232:235]
    s_waitcnt lgkmcnt(9)
    v_mfma_f32_16x16x32_bf16 v[236:239], v[192:195], v[124:127], v[236:239]
    ds_read_b64 v[102:103], v35 offset:1416
    v_mfma_f32_16x16x32_bf16 v[236:239], v[196:199], v[120:123], v[236:239]
    ds_read_b128 v[164:167], v36 offset:576
    v_mfma_f32_16x16x32_bf16 v[236:239], v[200:203], v[116:119], v[236:239]
    ds_read_b64 v[104:105], v35 offset:896
    s_waitcnt lgkmcnt(11)
    v_mfma_f32_16x16x32_bf16 v[236:239], v[204:207], v[112:115], v[236:239]
    ds_read_b64 v[106:107], v35 offset:904
    v_mfma_f32_16x16x32_bf16 v[240:243], v[196:199], v[124:127], v[240:243]
    v_mfma_f32_16x16x32_bf16 v[240:243], v[200:203], v[120:123], v[240:243]
    ds_read_b128 v[168:171], v36 offset:1088
    v_mfma_f32_16x16x32_bf16 v[240:243], v[204:207], v[116:119], v[240:243]
    ds_read_b64 v[108:109], v35 offset:384
    s_waitcnt lgkmcnt(13)
    v_mfma_f32_16x16x32_bf16 v[240:243], v[208:211], v[112:115], v[240:243]
    ds_read_b64 v[110:111], v35 offset:392
    v_mfma_f32_16x16x32_bf16 v[244:247], v[200:203], v[124:127], v[244:247]
    ds_read_b128 v[172:175], v36 offset:1600
    v_mfma_f32_16x16x32_bf16 v[244:247], v[204:207], v[120:123], v[244:247]
    v_mfma_f32_16x16x32_bf16 v[244:247], v[208:211], v[116:119], v[244:247]
    ds_read_b128 v[176:179], v36 offset:2112
    s_waitcnt lgkmcnt(14)
    v_mfma_f32_16x16x32_bf16 v[244:247], v[212:215], v[112:115], v[244:247]
    ds_read_b128 v[180:183], v36 offset:2624
    v_mfma_f32_16x16x32_bf16 v[248:251], v[204:207], v[124:127], v[248:251]
    ds_read_b128 v[184:187], v36 offset:3136
    v_mfma_f32_16x16x32_bf16 v[248:251], v[208:211], v[120:123], v[248:251]
    ds_read_b128 v[188:191], v36 offset:3648
    v_mfma_f32_16x16x32_bf16 v[248:251], v[212:215], v[116:119], v[248:251]
    v_mfma_f32_16x16x32_bf16 v[248:251], v[216:219], v[112:115], v[248:251]
    v_mfma_f32_16x16x32_bf16 v[252:255], v[208:211], v[124:127], v[252:255]
    v_mfma_f32_16x16x32_bf16 v[252:255], v[212:215], v[120:123], v[252:255]
    v_mfma_f32_16x16x32_bf16 v[252:255], v[216:219], v[116:119], v[252:255]
    s_waitcnt lgkmcnt(14)
    v_mfma_f32_16x16x32_bf16 v[252:255], v[220:223], v[112:115], v[252:255]
    s_waitcnt lgkmcnt(13)
    v_mfma_f32_16x16x32_bf16 v[224:227], v[160:163], v[96:99], v[224:227]
    s_waitcnt lgkmcnt(11)
    v_mfma_f32_16x16x32_bf16 v[228:231], v[160:163], v[100:103], v[228:231]
    ds_read_b128 v[192:195], v36 offset:0
    s_waitcnt lgkmcnt(11)
    v_mfma_f32_16x16x32_bf16 v[228:231], v[164:167], v[96:99], v[228:231]
    ds_read_b64 v[112:113], v35 offset:1856
    s_waitcnt lgkmcnt(10)
    v_mfma_f32_16x16x32_bf16 v[232:235], v[160:163], v[104:107], v[232:235]
    ds_read_b64 v[114:115], v35 offset:1864
    v_mfma_f32_16x16x32_bf16 v[232:235], v[164:167], v[100:103], v[232:235]
    ds_read_b64 v[116:117], v35 offset:1344
    s_waitcnt lgkmcnt(11)
    v_mfma_f32_16x16x32_bf16 v[232:235], v[168:171], v[96:99], v[232:235]
    s_waitcnt lgkmcnt(9)
    v_mfma_f32_16x16x32_bf16 v[236:239], v[160:163], v[108:111], v[236:239]
    ds_read_b64 v[118:119], v35 offset:1352
    v_mfma_f32_16x16x32_bf16 v[236:239], v[164:167], v[104:107], v[236:239]
    ds_read_b128 v[196:199], v36 offset:512
    v_mfma_f32_16x16x32_bf16 v[236:239], v[168:171], v[100:103], v[236:239]
    ds_read_b64 v[120:121], v35 offset:832
    s_waitcnt lgkmcnt(11)
    v_mfma_f32_16x16x32_bf16 v[236:239], v[172:175], v[96:99], v[236:239]
    ds_read_b64 v[122:123], v35 offset:840
    v_mfma_f32_16x16x32_bf16 v[240:243], v[164:167], v[108:111], v[240:243]
    v_mfma_f32_16x16x32_bf16 v[240:243], v[168:171], v[104:107], v[240:243]
    ds_read_b128 v[200:203], v36 offset:1024
    v_mfma_f32_16x16x32_bf16 v[240:243], v[172:175], v[100:103], v[240:243]
    ds_read_b64 v[124:125], v35 offset:320
    s_waitcnt lgkmcnt(13)
    v_mfma_f32_16x16x32_bf16 v[240:243], v[176:179], v[96:99], v[240:243]
    ds_read_b64 v[126:127], v35 offset:328
    v_mfma_f32_16x16x32_bf16 v[244:247], v[168:171], v[108:111], v[244:247]
    ds_read_b128 v[204:207], v36 offset:1536
    v_mfma_f32_16x16x32_bf16 v[244:247], v[172:175], v[104:107], v[244:247]
    v_mfma_f32_16x16x32_bf16 v[244:247], v[176:179], v[100:103], v[244:247]
    ds_read_b128 v[208:211], v36 offset:2048
    s_waitcnt lgkmcnt(14)
    v_mfma_f32_16x16x32_bf16 v[244:247], v[180:183], v[96:99], v[244:247]
    ds_read_b128 v[212:215], v36 offset:2560
    v_mfma_f32_16x16x32_bf16 v[248:251], v[172:175], v[108:111], v[248:251]
    ds_read_b128 v[216:219], v36 offset:3072
    v_mfma_f32_16x16x32_bf16 v[248:251], v[176:179], v[104:107], v[248:251]
    ds_read_b128 v[220:223], v36 offset:3584
    v_mfma_f32_16x16x32_bf16 v[248:251], v[180:183], v[100:103], v[248:251]
    v_mfma_f32_16x16x32_bf16 v[248:251], v[184:187], v[96:99], v[248:251]
    v_mfma_f32_16x16x32_bf16 v[252:255], v[176:179], v[108:111], v[252:255]
    v_mfma_f32_16x16x32_bf16 v[252:255], v[180:183], v[104:107], v[252:255]
    v_mfma_f32_16x16x32_bf16 v[252:255], v[184:187], v[100:103], v[252:255]
    s_waitcnt lgkmcnt(14)
    v_mfma_f32_16x16x32_bf16 v[252:255], v[188:191], v[96:99], v[252:255]
    s_mov_b64 exec, 1
    ds_write_b32 v39, v42 offset:32
    s_mov_b64 exec, -1
    s_waitcnt lgkmcnt(14)
    v_mfma_f32_16x16x32_bf16 v[224:227], v[192:195], v[112:115], v[224:227]
    s_waitcnt lgkmcnt(12)
    v_mfma_f32_16x16x32_bf16 v[228:231], v[192:195], v[116:119], v[228:231]
    s_waitcnt lgkmcnt(11)
    v_mfma_f32_16x16x32_bf16 v[228:231], v[196:199], v[112:115], v[228:231]
    s_waitcnt lgkmcnt(9)
    v_mfma_f32_16x16x32_bf16 v[232:235], v[192:195], v[120:123], v[232:235]
    v_mfma_f32_16x16x32_bf16 v[232:235], v[196:199], v[116:119], v[232:235]
    ds_read_b32 v50, v38 offset:32
    s_waitcnt lgkmcnt(9)
    v_mfma_f32_16x16x32_bf16 v[232:235], v[200:203], v[112:115], v[232:235]
    s_waitcnt lgkmcnt(7)
    v_mfma_f32_16x16x32_bf16 v[236:239], v[192:195], v[124:127], v[236:239]
    v_mfma_f32_16x16x32_bf16 v[236:239], v[196:199], v[120:123], v[236:239]
    v_mfma_f32_16x16x32_bf16 v[236:239], v[200:203], v[116:119], v[236:239]
    s_waitcnt lgkmcnt(6)
    v_mfma_f32_16x16x32_bf16 v[236:239], v[204:207], v[112:115], v[236:239]
    v_mfma_f32_16x16x32_bf16 v[240:243], v[196:199], v[124:127], v[240:243]
    s_waitcnt lgkmcnt(0)
    v_cmp_ne_u32 vcc, s52, v50
    v_mfma_f32_16x16x32_bf16 v[240:243], v[200:203], v[120:123], v[240:243]
    v_mfma_f32_16x16x32_bf16 v[240:243], v[204:207], v[116:119], v[240:243]
    v_mfma_f32_16x16x32_bf16 v[240:243], v[208:211], v[112:115], v[240:243]
    v_mfma_f32_16x16x32_bf16 v[244:247], v[200:203], v[124:127], v[244:247]
    v_mfma_f32_16x16x32_bf16 v[244:247], v[204:207], v[120:123], v[244:247]
    s_cbranch_vccz L_pass_12
    s_mov_b32 s96, 0
L_spin_13:
    ds_read_b32 v50, v38 offset:32
    s_add_u32 s96, s96, 1
    s_cmp_gt_u32 s96, 1048576
    s_waitcnt lgkmcnt(0)
    v_cmp_ne_u32 vcc, s52, v50
    s_cbranch_scc1 L_spun_14
    s_nop 3
    s_cbranch_vccnz L_spin_13
L_spun_14:
L_pass_12:
    v_mfma_f32_16x16x32_bf16 v[244:247], v[208:211], v[116:119], v[244:247]
    v_mfma_f32_16x16x32_bf16 v[244:247], v[212:215], v[112:115], v[244:247]
    v_mfma_f32_16x16x32_bf16 v[248:251], v[204:207], v[124:127], v[248:251]
    v_mfma_f32_16x16x32_bf16 v[248:251], v[208:211], v[120:123], v[248:251]
    v_mfma_f32_16x16x32_bf16 v[248:251], v[212:215], v[116:119], v[248:251]
    v_mfma_f32_16x16x32_bf16 v[248:251], v[216:219], v[112:115], v[248:251]
    v_mfma_f32_16x16x32_bf16 v[252:255], v[208:211], v[124:127], v[252:255]
    v_mfma_f32_16x16x32_bf16 v[252:255], v[212:215], v[120:123], v[252:255]
    v_mfma_f32_16x16x32_bf16 v[252:255], v[216:219], v[116:119], v[252:255]
    v_mfma_f32_16x16x32_bf16 v[252:255], v[220:223], v[112:115], v[252:255]
    s_setprio 0
    ds_write_b128 v40, v[224:227] offset:0
    ds_write_b128 v40, v[228:231] offset:1024
    ds_write_b128 v40, v[232:235] offset:2048
    ds_write_b128 v40, v[236:239] offset:3072
    ds_write_b128 v40, v[240:243] offset:4096
    ds_write_b128 v40, v[244:247] offset:5120
    ds_write_b128 v40, v[248:251] offset:6144
    ds_write_b128 v40, v[252:255] offset:7168
    s_mov_b64 exec, 1
    ds_write_b32 v39, v42 offset:48
    s_mov_b64 exec, -1
    s_mov_b32 s96, 0
L_spin_15:
    ds_read_b32 v50, v38 offset:48
    s_add_u32 s96, s96, 1
    s_cmp_gt_u32 s96, 1048576
    s_waitcnt lgkmcnt(0)
    v_cmp_ne_u32 vcc, s52, v50
    s_cbranch_scc1 L_spun_16
    s_nop 3
    s_cbranch_vccnz L_spin_15
L_spun_16:
    ds_read_b128 v[96:99], v41 offset:0
    ds_read_b128 v[100:103], v41 offset:8192
    ds_read_b128 v[104:107], v41 offset:16384
    ds_read_b128 v[108:111], v41 offset:24576
    ds_read_b128 v[112:115], v41 offset:1024
    ds_read_b128 v[116:119], v41 offset:9216
    ds_read_b128 v[120:123], v41 offset:17408
    ds_read_b128 v[124:127], v41 offset:25600
    s_waitcnt lgkmcnt(6)
    v_add_f32 v96, v96, v100
    s_waitcnt lgkmcnt(4)
    v_add_f32 v104, v104, v108
    v_add_f32 v97, v97, v101
    v_add_f32 v105, v105, v109
    v_add_f32 v98, v98, v102
    v_add_f32 v106, v106, v110
    v_add_f32 v99, v99, v103
    v_add_f32 v107, v107, v111
    v_cvt_pk_bf16_f32 v100, v96, v104
    v_cvt_pk_bf16_f32 v101, v97, v105
    v_cvt_pk_bf16_f32 v102, v98, v106
    v_cvt_pk_bf16_f32 v103, v99, v107
    buffer_store_dwordx4 v[100:103], v9, s[44:47], s73 offen offset:0 sc1
    s_waitcnt lgkmcnt(2)
    v_add_f32 v112, v112, v116
    s_waitcnt lgkmcnt(0)
    v_add_f32 v120, v120, v124
    v_add_f32 v113, v113, v117
    v_add_f32 v121, v121, v125
    v_add_f32 v114, v114, v118
    v_add_f32 v122, v122, v126
    v_add_f32 v115, v115, v119
    v_add_f32 v123, v123, v127
    v_cvt_pk_bf16_f32 v116, v112, v120
    v_cvt_pk_bf16_f32 v117, v113, v121
    v_cvt_pk_bf16_f32 v118, v114, v122
    v_cvt_pk_bf16_f32 v119, v115, v123
    buffer_store_dwordx4 v[116:119], v9, s[44:47], s73 offen offset:1024 sc1
    s_load_dwordx2 s[36:37], s[0:1], 0
    s_load_dwordx2 s[40:41], s[0:1], 104
    s_mov_b32 s38, 1835008
    s_mov_b32 s42, 1835008
    s_add_u32 s73, s58, 65536
    v_bfe_u32 v51, v0, 2, 1
    v_lshrrev_b32 v52, 3, v0
    v_and_b32 v53, 3, v0
    v_lshl_add_u32 v54, v51, 4, v52
    v_mul_u32_u24 v16, 896, v54
    v_lshl_add_u32 v16, v53, 4, v16
    v_lshlrev_b32 v20, 3, v54
    v_xor_b32 v18, s69, v51
    v_lshlrev_b32 v18, 3, v18
    v_lshl_add_u32 v18, v53, 1, v18
    v_xor_b32 v18, v18, v52
    s_lshl3_add_u32 s62, s68, 256
    v_add_u32 v54, s62, v54
    v_lshlrev_b32 v54, 8, v54
    v_lshl_add_u32 v18, v18, 4, v54
    v_xor_b32_e64 v19, 16, v18
    s_mul_i32 s62, s70, 2304
    s_add_u32 s62, s62, 55296
    v_mul_u32_u24 v17, 288, v53
    v_and_b32 v54, 60, v0
    v_add3_u32 v17, v17, v54, s62
    s_lshl3_add_u32 s74, s60, s68
    s_add_u32 s74, s74, 0
    s_lshl_b32 s75, s74, 6
    s_add_u32 s75, s75, 65536
    s_mul_i32 s74, s74, 7168
    s_lshl1_add_u32 s62, s61, s69
    s_lshl_b32 s62, s62, 6
    s_add_u32 s74, s74, s62
    s_mul_i32 s62, s70, 2304
    s_add_u32 s62, s62, 55296
    v_and_b32 v54, 32, v0
    v_lshl_add_u32 v54, v0, 3, v54
    v_add_u32 v10, s62, v54
    v_lshrrev_b32 v54, 3, v0
    v_lshlrev_b32 v54, 13, v54
    v_and_b32 v55, 7, v0
    v_lshl_add_u32 v12, v55, 4, v54
    v_lshlrev_b32 v54, 7, v0
    s_waitcnt vmcnt(0)
    s_atomic_swap s52, s[44:45], s76
    s_add_u32 s76, s76, 128
    s_atomic_swap s52, s[44:45], s76
    s_add_u32 s76, s76, 128
    s_atomic_swap s52, s[44:45], s76
    s_add_u32 s76, s76, 128
    s_atomic_swap s52, s[44:45], s76
    buffer_load_dword v21, v20, s[44:47], s75 offen sc1
    s_waitcnt lgkmcnt(0)
    buffer_load_dwordx4 v[24:27], v16, s[36:39], s74 offen
    s_buffer_load_dwordx16 s[80:95], s[44:47], s77 glc
    s_mov_b32 s96, 0
L_chk_17:
    s_waitcnt lgkmcnt(0)
    s_cmp_eq_u64 s[80:81], s[52:53]
    s_cbranch_scc0 L_retry_18
    s_cmp_eq_u64 s[82:83], s[52:53]
    s_cbranch_scc0 L_retry_18
    s_cmp_eq_u64 s[84:85], s[52:53]
    s_cbranch_scc0 L_retry_18
    s_cmp_eq_u64 s[86:87], s[52:53]
    s_cbranch_scc0 L_retry_18
    s_cmp_eq_u64 s[88:89], s[52:53]
    s_cbranch_scc0 L_retry_18
    s_cmp_eq_u64 s[90:91], s[52:53]
    s_cbranch_scc0 L_retry_18
    s_cmp_eq_u64 s[92:93], s[52:53]
    s_cbranch_scc0 L_retry_18
    s_cmp_eq_u64 s[94:95], s[52:53]
    s_cbranch_scc1 L_chkd_19
L_retry_18:
    s_sleep 3
    s_buffer_load_dwordx16 s[80:95], s[44:47], s77 glc
    s_add_u32 s96, s96, 1
    s_cmp_le_u32 s96, 131072
    s_cbranch_scc1 L_chk_17
    s_waitcnt lgkmcnt(0)
L_chkd_19:
    s_setprio 1
    buffer_load_dwordx4 v[64:67], v12, s[44:47], s58 offen sc1
    buffer_load_dwordx4 v[68:71], v12, s[44:47], s73 offen sc1
    s_waitcnt vmcnt(1)
    ds_write2_b64 v10, v[64:65], v[66:67] offset0:0 offset1:144
    s_waitcnt vmcnt(0)
    ds_write2_b64 v10, v[68:69], v[70:71] offset0:72 offset1:216
    s_mov_b64 exec, 1
    ds_write_b32 v39, v42 offset:112
    s_mov_b64 exec, -1
    ds_read_b32 v28, v17 offset:0
    ds_read_b32 v29, v17 offset:64
    ds_read_b32 v30, v17 offset:128
    ds_read_b32 v31, v17 offset:192
    v_and_b32 v21, 0xffff0000, v21
    v_rcp_f32 v21, v21
    v_lshlrev_b32 v128, 16, v24
    v_and_b32 v129, 0xffff0000, v24
    v_lshlrev_b32 v130, 16, v25
    v_and_b32 v131, 0xffff0000, v25
    v_lshlrev_b32 v132, 16, v26
    v_and_b32 v133, 0xffff0000, v26
    v_lshlrev_b32_e64 v134, 16, v27
    v_and_b32 v135, 0xffff0000, v27
    v_mul_f32 v22, 3216550459, v21
    v_mul_f32 v23, 3216550459, v21
    s_waitcnt lgkmcnt(3)
    v_lshlrev_b32 v136, 16, v28
    v_and_b32 v137, 0xffff0000, v28
    s_waitcnt lgkmcnt(2)
    v_lshlrev_b32 v138, 16, v29
    v_and_b32 v139, 0xffff0000, v29
    s_waitcnt lgkmcnt(1)
    v_lshlrev_b32 v140, 16, v30
    v_and_b32 v141, 0xffff0000, v30
    s_waitcnt lgkmcnt(0)
    v_lshlrev_b32 v142, 16, v31
    v_and_b32 v143, 0xffff0000, v31
    v_mul_f32 v136, v136, v21
    v_mul_f32 v137, v137, v21
    v_mul_f32 v138, v138, v21
    v_mul_f32 v139, v139, v21
    v_mul_f32 v140, v140, v21
    v_mul_f32 v141, v141, v21
    v_mul_f32 v142, v142, v21
    v_mul_f32 v143, v143, v21
    s_mov_b32 s96, 0
L_spin_20:
    s_sleep 1
    ds_read_b32 v50, v38 offset:80
    s_add_u32 s96, s96, 1
    s_cmp_gt_u32 s96, 1048576
    s_waitcnt lgkmcnt(0)
    v_cmp_ne_u32 vcc, s52, v50
    s_cbranch_scc1 L_spun_21
    s_nop 3
    s_cbranch_vccnz L_spin_20
L_spun_21:
    s_setprio 0
    ds_read_b128 v[160:163], v18 offset:0
    ds_read_b128 v[164:167], v19 offset:0
    ds_read_b128 v[168:171], v18 offset:8192
    ds_read_b128 v[172:175], v19 offset:8192
    ds_read_b128 v[176:179], v18 offset:16384
    ds_read_b128 v[180:183], v19 offset:16384
    ds_read_b128 v[184:187], v18 offset:24576
    ds_read_b128 v[188:191], v19 offset:24576
    s_waitcnt lgkmcnt(5)
    v_pk_add_f32 v[160:161], v[160:161], v[168:169]
    v_pk_add_f32 v[162:163], v[162:163], v[170:171]
    s_waitcnt lgkmcnt(4)
    v_pk_add_f32 v[164:165], v[164:165], v[172:173]
    v_pk_add_f32 v[166:167], v[166:167], v[174:175]
    s_waitcnt lgkmcnt(1)
    v_pk_add_f32 v[176:177], v[176:177], v[184:185]
    v_pk_add_f32 v[178:179], v[178:179], v[186:187]
    s_waitcnt lgkmcnt(0)
    s_nop 0
    v_pk_add_f32 v[180:181], v[180:181], v[188:189]
    v_pk_add_f32 v[182:183], v[182:183], v[190:191]
    v_pk_add_f32 v[160:161], v[160:161], v[176:177]
    v_pk_add_f32 v[162:163], v[162:163], v[178:179]
    v_pk_add_f32 v[164:165], v[164:165], v[180:181]
    v_pk_add_f32 v[166:167], v[166:167], v[182:183]
    v_pk_mul_f32 v[168:169], v[160:161], v[22:23]
    v_pk_mul_f32 v[170:171], v[162:163], v[22:23]
    v_pk_mul_f32 v[172:173], v[164:165], v[22:23]
    v_pk_mul_f32 v[174:175], v[166:167], v[22:23]
    v_exp_f32 v168, v168
    v_exp_f32 v169, v169
    v_exp_f32 v170, v170
    v_exp_f32 v171, v171
    v_exp_f32 v172, v172
    v_exp_f32 v173, v173
    v_exp_f32 v174, v174
    v_exp_f32 v175, v175
    v_pk_mul_f32 v[160:161], v[160:161], v[136:137]
    v_pk_mul_f32 v[162:163], v[162:163], v[138:139]
    v_pk_mul_f32 v[164:165], v[164:165], v[140:141]
    v_pk_mul_f32 v[166:167], v[166:167], v[142:143]
    v_pk_add_f32 v[168:169], v[168:169], 1.0 op_sel_hi:[1,0]
    v_pk_add_f32 v[170:171], v[170:171], 1.0 op_sel_hi:[1,0]
    v_pk_add_f32 v[172:173], v[172:173], 1.0 op_sel_hi:[1,0]
    v_pk_add_f32 v[174:175], v[174:175], 1.0 op_sel_hi:[1,0]
    v_rcp_f32 v168, v168
    v_rcp_f32 v169, v169
    v_rcp_f32 v170, v170
    v_rcp_f32 v171, v171
    v_rcp_f32 v172, v172
    v_rcp_f32 v173, v173
    v_rcp_f32 v174, v174
    v_rcp_f32 v175, v175
    v_pk_fma_f32 v[160:161], v[160:161], v[168:169], v[128:129]
    v_pk_fma_f32 v[162:163], v[162:163], v[170:171], v[130:131]
    v_pk_fma_f32 v[164:165], v[164:165], v[172:173], v[132:133]
    v_pk_fma_f32 v[166:167], v[166:167], v[174:175], v[134:135]
    v_cvt_pk_bf16_f32 v176, v160, v161
    v_cvt_pk_bf16_f32 v177, v162, v163
    v_cvt_pk_bf16_f32 v178, v164, v165
    v_cvt_pk_bf16_f32 v179, v166, v167
    buffer_store_dwordx4 v[176:179], v16, s[40:43], s74 offen nt
    s_endpgm
.p2align 12
L_bodyA:
    s_mov_b64 exec, -1
    v_and_b32 v24, 15, v0
    v_lshrrev_b32 v25, 4, v0
    v_bfe_u32 v26, v0, 1, 3
    v_xor_b32 v26, v25, v26
    v_lshl_add_u32 v26, v24, 3, v26
    s_add_u32 s78, s68, 12
    s_lshl_b32 s78, s78, 13
    v_lshl_add_u32 v9, v26, 4, s78
    v_xor_b32 v10, 64, v9
    s_lshl_b32 s73, s54, 13
    s_add_u32 s73, s73, 65536
    s_mov_b32 s76, 0
    v_bfe_u32 v26, v0, 2, 2
    v_lshl_add_u32 v27, v25, 3, v26
    v_and_b32 v25, 1, v25
    v_lshl_add_u32 v25, v26, 1, v25
    s_lshl2_add_u32 s79, s69, 3072
    v_xor_b32 v25, s79, v25
    v_lshl_add_u32 v25, v27, 3, v25
    v_and_b32 v26, 3, v0
    v_lshl_add_u32 v25, v25, 2, v26
    v_lshlrev_b32 v11, 3, v25
    v_xor_b32 v12, 32, v11
    v_xor_b32 v13, 64, v11
    v_xor_b32 v14, 96, v11
    v_lshrrev_b32 v27, 2, v0
    v_bfe_u32 v28, v0, 3, 2
    v_lshl_add_u32 v27, v27, 2, v28
    v_and_b32 v28, 3, v0
    v_lshl_add_u32 v27, v27, 2, v28
    s_lshl_b32 s78, s54, 13
    v_lshl_add_u32 v15, v27, 3, s78
    s_mov_b32 s40, s28
    s_mov_b32 s41, s29
    s_mov_b32 s42, 1605632
    s_mov_b32 s43, 0x20000
    s_lshl1_add_u32 s79, s58, s69
    s_lshl_b32 s78, s79, 7
    v_xor_b32_e64 v31, s76, v0
    v_lshl_add_u32 v30, v31, 1, s78
    global_load_ushort v30, v30, s[26:27]
    s_add_u32 m0, s66, 135168
    s_nop 0
    buffer_load_dwordx4 v5, s[36:39], s64 offen offset:0 lds
    buffer_load_dwordx4 v6, s[36:39], s64 offen offset:1024 lds
    buffer_load_dwordx4 v7, s[36:39], s64 offen offset:2048 lds
    buffer_load_dwordx4 v8, s[36:39], s64 offen offset:3072 lds
    s_add_u32 s64, s64, s65
    s_cmp_eq_u32 s56, 5
    s_cselect_b32 s62, s67, 0
    s_sub_u32 s64, s64, s62
    s_add_u32 m0, s66, 32768
    s_nop 0
    buffer_load_dwordx4 v1, s[36:39], s64 offen offset:0 lds
    buffer_load_dwordx4 v2, s[36:39], s64 offen offset:1024 lds
    buffer_load_dwordx4 v3, s[36:39], s64 offen offset:2048 lds
    buffer_load_dwordx4 v4, s[36:39], s64 offen offset:3072 lds
    s_add_u32 m0, s66, 36864
    s_nop 0
    buffer_load_dwordx4 v5, s[36:39], s64 offen offset:0 lds
    buffer_load_dwordx4 v6, s[36:39], s64 offen offset:1024 lds
    buffer_load_dwordx4 v7, s[36:39], s64 offen offset:2048 lds
    buffer_load_dwordx4 v8, s[36:39], s64 offen offset:3072 lds
    s_add_u32 s64, s64, s65
    s_cmp_eq_u32 s56, 4
    s_cselect_b32 s62, s67, 0
    s_sub_u32 s64, s64, s62
    s_add_u32 m0, s66, 65536
    s_nop 0
    buffer_load_dwordx4 v1, s[36:39], s64 offen offset:0 lds
    buffer_load_dwordx4 v2, s[36:39], s64 offen offset:1024 lds
    buffer_load_dwordx4 v3, s[36:39], s64 offen offset:2048 lds
    buffer_load_dwordx4 v4, s[36:39], s64 offen offset:3072 lds
    s_add_u32 m0, s66, 69632
    s_nop 0
    buffer_load_dwordx4 v5, s[36:39], s64 offen offset:0 lds
    buffer_load_dwordx4 v6, s[36:39], s64 offen offset:1024 lds
    buffer_load_dwordx4 v7, s[36:39], s64 offen offset:2048 lds
    buffer_load_dwordx4 v8, s[36:39], s64 offen offset:3072 lds
    s_add_u32 s64, s64, s65
    s_cmp_eq_u32 s56, 3
    s_cselect_b32 s62, s67, 0
    s_sub_u32 s64, s64, s62
    v_xor_b32 v16, 32, v15
    v_xor_b32 v17, 64, v15
    v_xor_b32 v18, 96, v15
    s_waitcnt lgkmcnt(0)
    s_add_u32 s52, s52, 2654435761
    s_mov_b32 s53, s52
    v_mov_b32 v24, s52
    s_mov_b64 exec, 0
    s_cmp_eq_u32 s54, 0
    s_cbranch_scc1 L_hop1
    s_cmp_eq_u32 s54, 1
    s_cbranch_scc1 L_hop2
    s_cmp_eq_u32 s54, 2
    s_cbranch_scc1 L_hop3
    s_branch L_hop4
L_hopped:
    s_mov_b64 exec, -1
    s_waitcnt vmcnt(25)
    s_waitcnt lgkmcnt(0)
    s_barrier
    ds_read_b64_tr_b16 v[224:225], v11 offset:16384
    ds_read_b64_tr_b16 v[226:227], v11 offset:17408
    ds_read_b128 v[96:99], v9 offset:0
    ds_read_b64_tr_b16 v[228:229], v11 offset:24576
    ds_read_b64_tr_b16 v[230:231], v11 offset:25600
    ds_read_b128 v[100:103], v10 offset:0
    ds_read_b64_tr_b16 v[232:233], v12 offset:16384
    ds_read_b64_tr_b16 v[234:235], v12 offset:17408
    ds_read_b64_tr_b16 v[236:237], v12 offset:24576
    ds_read_b64_tr_b16 v[238:239], v12 offset:25600
    ds_read_b64_tr_b16 v[240:241], v13 offset:16384
    ds_read_b64_tr_b16 v[242:243], v13 offset:17408
    ds_read_b64_tr_b16 v[244:245], v13 offset:24576
    ds_read_b64_tr_b16 v[246:247], v13 offset:25600
    ds_read_b64_tr_b16 v[248:249], v14 offset:16384
    ds_read_b64_tr_b16 v[250:251], v14 offset:17408
    ds_read_b64_tr_b16 v[252:253], v14 offset:24576
    ds_read_b64_tr_b16 v[254:255], v14 offset:25600
    s_waitcnt lgkmcnt(14)
    v_mfma_f32_16x16x32_bf16 v[32:35], v[224:227], v[96:99], 0
    ds_read_b128 v[104:107], v9 offset:2048
    s_lshl1_add_u32 s63, s57, s68
    s_waitcnt lgkmcnt(13)
    v_mfma_f32_16x16x32_bf16 v[32:35], v[228:231], v[100:103], v[32:35]
    ds_read_b128 v[108:111], v10 offset:2048
    s_waitcnt lgkmcnt(12)
    v_mfma_f32_16x16x32_bf16 v[36:39], v[232:235], v[96:99], 0
    s_lshl_b32 s78, s63, 9
    s_waitcnt lgkmcnt(10)
    v_mfma_f32_16x16x32_bf16 v[36:39], v[236:239], v[100:103], v[36:39]
    s_waitcnt lgkmcnt(8)
    v_mfma_f32_16x16x32_bf16 v[64:67], v[240:243], v[96:99], 0
    s_add_u32 s78, s78, 65536
    s_waitcnt lgkmcnt(6)
    v_mfma_f32_16x16x32_bf16 v[64:67], v[244:247], v[100:103], v[64:67]
    s_waitcnt lgkmcnt(4)
    v_mfma_f32_16x16x32_bf16 v[68:71], v[248:251], v[96:99], 0
    v_lshl_add_u32 v26, v0, 3, s78
    s_waitcnt lgkmcnt(2)
    v_mfma_f32_16x16x32_bf16 v[68:71], v[252:255], v[100:103], v[68:71]
    s_lshl1_add_u32 s79, s58, s69
    s_waitcnt lgkmcnt(1)
    v_mfma_f32_16x16x32_bf16 v[40:43], v[224:227], v[104:107], 0
    ds_read_b128 v[96:99], v9 offset:4096
    s_waitcnt lgkmcnt(1)
    v_mfma_f32_16x16x32_bf16 v[40:43], v[228:231], v[108:111], v[40:43]
    ds_read_b128 v[100:103], v10 offset:4096
    s_lshl_b32 s78, s79, 9
    v_mfma_f32_16x16x32_bf16 v[44:47], v[232:235], v[104:107], 0
    v_mfma_f32_16x16x32_bf16 v[44:47], v[236:239], v[108:111], v[44:47]
    s_add_u32 s78, s78, 81920
    v_mfma_f32_16x16x32_bf16 v[72:75], v[240:243], v[104:107], 0
    v_mfma_f32_16x16x32_bf16 v[72:75], v[244:247], v[108:111], v[72:75]
    v_lshl_add_u32 v27, v31, 3, s78
    v_mfma_f32_16x16x32_bf16 v[76:79], v[248:251], v[104:107], 0
    v_mfma_f32_16x16x32_bf16 v[76:79], v[252:255], v[108:111], v[76:79]
    s_mul_i32 s70, s63, 28
    s_waitcnt lgkmcnt(1)
    v_mfma_f32_16x16x32_bf16 v[48:51], v[224:227], v[96:99], 0
    ds_read_b128 v[104:107], v9 offset:6144
    s_add_u32 s70, s70, s79
    s_waitcnt lgkmcnt(1)
    v_mfma_f32_16x16x32_bf16 v[48:51], v[228:231], v[100:103], v[48:51]
    ds_read_b128 v[108:111], v10 offset:6144
    v_mfma_f32_16x16x32_bf16 v[52:55], v[232:235], v[96:99], 0
    s_mul_i32 s70, s70, 4096
    v_mfma_f32_16x16x32_bf16 v[52:55], v[236:239], v[100:103], v[52:55]
    v_mfma_f32_16x16x32_bf16 v[80:83], v[240:243], v[96:99], 0
    s_add_u32 s70, s70, 6291456
    v_mfma_f32_16x16x32_bf16 v[80:83], v[244:247], v[100:103], v[80:83]
    v_mfma_f32_16x16x32_bf16 v[84:87], v[248:251], v[96:99], 0
    s_mul_i32 s78, s79, 37
    v_mfma_f32_16x16x32_bf16 v[84:87], v[252:255], v[100:103], v[84:87]
    s_lshr_b32 s78, s78, 8
    s_waitcnt vmcnt(16)
    s_waitcnt lgkmcnt(0)
    s_barrier
    ds_read_b64_tr_b16 v[112:113], v11 offset:49152
    ds_read_b64_tr_b16 v[114:115], v11 offset:50176
    ds_read_b128 v[96:99], v9 offset:32768
    v_mfma_f32_16x16x32_bf16 v[56:59], v[224:227], v[104:107], 0
    ds_read_b64_tr_b16 v[116:117], v11 offset:57344
    ds_read_b64_tr_b16 v[118:119], v11 offset:58368
    v_mfma_f32_16x16x32_bf16 v[56:59], v[228:231], v[108:111], v[56:59]
    ds_read_b128 v[100:103], v10 offset:32768
    ds_read_b64_tr_b16 v[120:121], v12 offset:49152
    s_mul_i32 s78, s78, 25
    v_mfma_f32_16x16x32_bf16 v[60:63], v[232:235], v[104:107], 0
    ds_read_b64_tr_b16 v[122:123], v12 offset:50176
    ds_read_b64_tr_b16 v[124:125], v12 offset:57344
    v_mfma_f32_16x16x32_bf16 v[60:63], v[236:239], v[108:111], v[60:63]
    ds_read_b64_tr_b16 v[126:127], v12 offset:58368
    ds_read_b64_tr_b16 v[128:129], v13 offset:49152
    s_add_u32 s78, s78, s79
    v_mfma_f32_16x16x32_bf16 v[88:91], v[240:243], v[104:107], 0
    ds_read_b64_tr_b16 v[130:131], v13 offset:50176
    ds_read_b64_tr_b16 v[132:133], v13 offset:57344
    v_mfma_f32_16x16x32_bf16 v[88:91], v[244:247], v[108:111], v[88:91]
    ds_read_b64_tr_b16 v[134:135], v13 offset:58368
    ds_read_b64_tr_b16 v[136:137], v14 offset:49152
    v_mfma_f32_16x16x32_bf16 v[92:95], v[248:251], v[104:107], 0
    ds_read_b64_tr_b16 v[138:139], v14 offset:50176
    ds_read_b64_tr_b16 v[140:141], v14 offset:57344
    s_lshl_b32 s71, s63, 9
    v_mfma_f32_16x16x32_bf16 v[92:95], v[252:255], v[108:111], v[92:95]
    ds_read_b64_tr_b16 v[142:143], v14 offset:58368
    s_waitcnt lgkmcnt(14)
    v_mfma_f32_16x16x32_bf16 v[32:35], v[112:115], v[96:99], v[32:35]
    ds_read_b128 v[104:107], v9 offset:34816
    s_add_u32 s71, s71, s78
    s_waitcnt lgkmcnt(13)
    v_mfma_f32_16x16x32_bf16 v[32:35], v[116:119], v[100:103], v[32:35]
    ds_read_b128 v[108:111], v10 offset:34816
    s_waitcnt lgkmcnt(12)
    v_mfma_f32_16x16x32_bf16 v[36:39], v[120:123], v[96:99], v[36:39]
    s_lshl2_add_u32 s71, s71, 131072
    s_waitcnt lgkmcnt(10)
    v_mfma_f32_16x16x32_bf16 v[36:39], v[124:127], v[100:103], v[36:39]
    s_waitcnt lgkmcnt(8)
    v_mfma_f32_16x16x32_bf16 v[64:67], v[128:131], v[96:99], v[64:67]
    s_waitcnt lgkmcnt(6)
    v_mfma_f32_16x16x32_bf16 v[64:67], v[132:135], v[100:103], v[64:67]
    s_lshl2_add_u32 s60, s55, s3
    s_waitcnt lgkmcnt(4)
    v_mfma_f32_16x16x32_bf16 v[68:71], v[136:139], v[96:99], v[68:71]
    s_waitcnt lgkmcnt(2)
    v_mfma_f32_16x16x32_bf16 v[68:71], v[140:143], v[100:103], v[68:71]
    s_lshl4_add_u32 s72, s60, s54
    s_waitcnt lgkmcnt(1)
    v_mfma_f32_16x16x32_bf16 v[40:43], v[112:115], v[104:107], v[40:43]
    ds_read_b128 v[96:99], v9 offset:36864
    s_waitcnt lgkmcnt(1)
    v_mfma_f32_16x16x32_bf16 v[40:43], v[116:119], v[108:111], v[40:43]
    ds_read_b128 v[100:103], v10 offset:36864
    s_lshl_b32 s72, s72, 7
    v_mfma_f32_16x16x32_bf16 v[44:47], v[120:123], v[104:107], v[44:47]
    v_mfma_f32_16x16x32_bf16 v[44:47], v[124:127], v[108:111], v[44:47]
    v_mfma_f32_16x16x32_bf16 v[72:75], v[128:131], v[104:107], v[72:75]
    s_add_u32 s72, s72, 131072
    v_mfma_f32_16x16x32_bf16 v[72:75], v[132:135], v[108:111], v[72:75]
    v_mfma_f32_16x16x32_bf16 v[76:79], v[136:139], v[104:107], v[76:79]
    v_lshlrev_b32 v21, 4, v0
    v_mfma_f32_16x16x32_bf16 v[76:79], v[140:143], v[108:111], v[76:79]
    s_waitcnt lgkmcnt(1)
    v_mfma_f32_16x16x32_bf16 v[48:51], v[112:115], v[96:99], v[48:51]
    ds_read_b128 v[104:107], v9 offset:38912
    v_lshrrev_b32 v28, 3, v0
    s_waitcnt lgkmcnt(1)
    v_mfma_f32_16x16x32_bf16 v[48:51], v[116:119], v[100:103], v[48:51]
    ds_read_b128 v[108:111], v10 offset:38912
    v_mfma_f32_16x16x32_bf16 v[52:55], v[120:123], v[96:99], v[52:55]
    v_mfma_f32_16x16x32_bf16 v[52:55], v[124:127], v[100:103], v[52:55]
    v_mul_u32_u24 v28, 896, v28
    v_mfma_f32_16x16x32_bf16 v[80:83], v[128:131], v[96:99], v[80:83]
    v_mfma_f32_16x16x32_bf16 v[80:83], v[132:135], v[100:103], v[80:83]
    v_bfe_u32 v25, v0, 4, 2
    v_mfma_f32_16x16x32_bf16 v[84:87], v[136:139], v[96:99], v[84:87]
    v_mfma_f32_16x16x32_bf16 v[84:87], v[140:143], v[100:103], v[84:87]
    v_lshlrev_b32 v25, 1, v25
    s_waitcnt vmcnt(8)
    s_waitcnt lgkmcnt(0)
    s_barrier
    v_xor_b32 v9, 0x10000, v9
    v_xor_b32 v10, 0x10000, v10
    v_xor_b32 v11, 0x10000, v11
    v_xor_b32 v12, 0x10000, v12
    v_xor_b32 v13, 0x10000, v13
    v_xor_b32 v14, 0x10000, v14
    ds_read_b64_tr_b16 v[224:225], v11 offset:16384
    ds_read_b64_tr_b16 v[226:227], v11 offset:17408
    ds_read_b128 v[96:99], v9 offset:0
    v_mfma_f32_16x16x32_bf16 v[56:59], v[112:115], v[104:107], v[56:59]
    ds_read_b64_tr_b16 v[228:229], v11 offset:24576
    ds_read_b64_tr_b16 v[230:231], v11 offset:25600
    v_mfma_f32_16x16x32_bf16 v[56:59], v[116:119], v[108:111], v[56:59]
    ds_read_b128 v[100:103], v10 offset:0
    ds_read_b64_tr_b16 v[232:233], v12 offset:16384
    v_xor_b32_e64 v25, v0, v25
    v_mfma_f32_16x16x32_bf16 v[60:63], v[120:123], v[104:107], v[60:63]
    ds_read_b64_tr_b16 v[234:235], v12 offset:17408
    ds_read_b64_tr_b16 v[236:237], v12 offset:24576
    v_mfma_f32_16x16x32_bf16 v[60:63], v[124:127], v[108:111], v[60:63]
    ds_read_b64_tr_b16 v[238:239], v12 offset:25600
    ds_read_b64_tr_b16 v[240:241], v13 offset:16384
    v_and_b32_e64 v25, 7, v25
    v_mfma_f32_16x16x32_bf16 v[88:91], v[128:131], v[104:107], v[88:91]
    ds_read_b64_tr_b16 v[242:243], v13 offset:17408
    ds_read_b64_tr_b16 v[244:245], v13 offset:24576
    v_mfma_f32_16x16x32_bf16 v[88:91], v[132:135], v[108:111], v[88:91]
    ds_read_b64_tr_b16 v[246:247], v13 offset:25600
    ds_read_b64_tr_b16 v[248:249], v14 offset:16384
    v_mfma_f32_16x16x32_bf16 v[92:95], v[136:139], v[104:107], v[92:95]
    ds_read_b64_tr_b16 v[250:251], v14 offset:17408
    ds_read_b64_tr_b16 v[252:253], v14 offset:24576
    v_lshl_add_u32 v19, v25, 4, v28
    v_mfma_f32_16x16x32_bf16 v[92:95], v[140:143], v[108:111], v[92:95]
    ds_read_b64_tr_b16 v[254:255], v14 offset:25600
    s_waitcnt lgkmcnt(14)
    v_mfma_f32_16x16x32_bf16 v[32:35], v[224:227], v[96:99], v[32:35]
    ds_read_b128 v[104:107], v9 offset:2048
    v_add_u32 v20, 6144, v19
    s_waitcnt lgkmcnt(13)
    v_mfma_f32_16x16x32_bf16 v[32:35], v[228:231], v[100:103], v[32:35]
    ds_read_b128 v[108:111], v10 offset:2048
    s_waitcnt lgkmcnt(12)
    v_mfma_f32_16x16x32_bf16 v[36:39], v[232:235], v[96:99], v[36:39]
    s_lshl2_add_u32 s74, s60, s54
    s_waitcnt lgkmcnt(10)
    v_mfma_f32_16x16x32_bf16 v[36:39], v[236:239], v[100:103], v[36:39]
    s_waitcnt lgkmcnt(8)
    v_mfma_f32_16x16x32_bf16 v[64:67], v[240:243], v[96:99], v[64:67]
    s_waitcnt lgkmcnt(6)
    v_mfma_f32_16x16x32_bf16 v[64:67], v[244:247], v[100:103], v[64:67]
    s_mul_i32 s74, s74, 28672
    s_waitcnt lgkmcnt(4)
    v_mfma_f32_16x16x32_bf16 v[68:71], v[248:251], v[96:99], v[68:71]
    s_waitcnt lgkmcnt(2)
    v_mfma_f32_16x16x32_bf16 v[68:71], v[252:255], v[100:103], v[68:71]
    s_add_u32 s74, s74, 6291456
    s_waitcnt lgkmcnt(1)
    v_mfma_f32_16x16x32_bf16 v[40:43], v[224:227], v[104:107], v[40:43]
    ds_read_b128 v[96:99], v9 offset:4096
    s_waitcnt lgkmcnt(1)
    v_mfma_f32_16x16x32_bf16 v[40:43], v[228:231], v[108:111], v[40:43]
    ds_read_b128 v[100:103], v10 offset:4096
    s_mul_i32 s75, s54, 3136
    v_mfma_f32_16x16x32_bf16 v[44:47], v[232:235], v[104:107], v[44:47]
    v_mfma_f32_16x16x32_bf16 v[44:47], v[236:239], v[108:111], v[44:47]
    v_mfma_f32_16x16x32_bf16 v[72:75], v[240:243], v[104:107], v[72:75]
    s_add_u32 s75, s75, s61
    v_mfma_f32_16x16x32_bf16 v[72:75], v[244:247], v[108:111], v[72:75]
    v_mfma_f32_16x16x32_bf16 v[76:79], v[248:251], v[104:107], v[76:79]
    s_lshl_b32 s75, s75, 7
    v_mfma_f32_16x16x32_bf16 v[76:79], v[252:255], v[108:111], v[76:79]
    s_waitcnt lgkmcnt(1)
    v_mfma_f32_16x16x32_bf16 v[48:51], v[224:227], v[96:99], v[48:51]
    ds_read_b128 v[104:107], v9 offset:6144
    s_lshl2_add_u32 s78, s54, 64512
    s_waitcnt lgkmcnt(1)
    v_mfma_f32_16x16x32_bf16 v[48:51], v[228:231], v[100:103], v[48:51]
    ds_read_b128 v[108:111], v10 offset:6144
    v_mfma_f32_16x16x32_bf16 v[52:55], v[232:235], v[96:99], v[52:55]
    v_mfma_f32_16x16x32_bf16 v[52:55], v[236:239], v[100:103], v[52:55]
    v_mov_b32 v29, s78
    v_mfma_f32_16x16x32_bf16 v[80:83], v[240:243], v[96:99], v[80:83]
    v_mfma_f32_16x16x32_bf16 v[80:83], v[244:247], v[100:103], v[80:83]
    v_mov_b32_e64 v202, 0
    v_mfma_f32_16x16x32_bf16 v[84:87], v[248:251], v[96:99], v[84:87]
    v_mfma_f32_16x16x32_bf16 v[84:87], v[252:255], v[100:103], v[84:87]
    v_mov_b32 v203, 0
    s_waitcnt vmcnt(0)
    s_waitcnt lgkmcnt(0)
    s_barrier
    ds_read_b64_tr_b16 v[112:113], v11 offset:49152
    ds_read_b64_tr_b16 v[114:115], v11 offset:50176
    ds_read_b128 v[96:99], v9 offset:32768
    v_mfma_f32_16x16x32_bf16 v[56:59], v[224:227], v[104:107], v[56:59]
    ds_read_b64_tr_b16 v[116:117], v11 offset:57344
    ds_read_b64_tr_b16 v[118:119], v11 offset:58368
    v_mfma_f32_16x16x32_bf16 v[56:59], v[228:231], v[108:111], v[56:59]
    ds_read_b128 v[100:103], v10 offset:32768
    ds_read_b64_tr_b16 v[120:121], v12 offset:49152
    v_mov_b32_e64 v204, 0
    v_mfma_f32_16x16x32_bf16 v[60:63], v[232:235], v[104:107], v[60:63]
    ds_read_b64_tr_b16 v[122:123], v12 offset:50176
    ds_read_b64_tr_b16 v[124:125], v12 offset:57344
    v_mfma_f32_16x16x32_bf16 v[60:63], v[236:239], v[108:111], v[60:63]
    ds_read_b64_tr_b16 v[126:127], v12 offset:58368
    ds_read_b64_tr_b16 v[128:129], v13 offset:49152
    v_mov_b32_e64 v205, 0
    v_mfma_f32_16x16x32_bf16 v[88:91], v[240:243], v[104:107], v[88:91]
    ds_read_b64_tr_b16 v[130:131], v13 offset:50176
    ds_read_b64_tr_b16 v[132:133], v13 offset:57344
    v_mfma_f32_16x16x32_bf16 v[88:91], v[244:247], v[108:111], v[88:91]
    ds_read_b64_tr_b16 v[134:135], v13 offset:58368
    ds_read_b64_tr_b16 v[136:137], v14 offset:49152
    v_mfma_f32_16x16x32_bf16 v[92:95], v[248:251], v[104:107], v[92:95]
    ds_read_b64_tr_b16 v[138:139], v14 offset:50176
    ds_read_b64_tr_b16 v[140:141], v14 offset:57344
    v_mov_b32_e64 v206, 0
    v_mfma_f32_16x16x32_bf16 v[92:95], v[252:255], v[108:111], v[92:95]
    ds_read_b64_tr_b16 v[142:143], v14 offset:58368
    s_waitcnt lgkmcnt(14)
    v_mfma_f32_16x16x32_bf16 v[32:35], v[112:115], v[96:99], v[32:35]
    ds_read_b128 v[104:107], v9 offset:34816
    v_mov_b32_e64 v207, 0
    s_waitcnt lgkmcnt(13)
    v_mfma_f32_16x16x32_bf16 v[32:35], v[116:119], v[100:103], v[32:35]
    ds_read_b128 v[108:111], v10 offset:34816
    s_waitcnt lgkmcnt(12)
    v_mfma_f32_16x16x32_bf16 v[36:39], v[120:123], v[96:99], v[36:39]
    v_mov_b32 v194, 0
    s_waitcnt lgkmcnt(10)
    v_mfma_f32_16x16x32_bf16 v[36:39], v[124:127], v[100:103], v[36:39]
    s_waitcnt lgkmcnt(8)
    v_mfma_f32_16x16x32_bf16 v[64:67], v[128:131], v[96:99], v[64:67]
    s_waitcnt lgkmcnt(6)
    v_mfma_f32_16x16x32_bf16 v[64:67], v[132:135], v[100:103], v[64:67]
    v_mov_b32 v195, 0
    s_waitcnt lgkmcnt(4)
    v_mfma_f32_16x16x32_bf16 v[68:71], v[136:139], v[96:99], v[68:71]
    s_waitcnt lgkmcnt(2)
    v_mfma_f32_16x16x32_bf16 v[68:71], v[140:143], v[100:103], v[68:71]
    v_mov_b32 v196, 0
    s_waitcnt lgkmcnt(1)
    v_mfma_f32_16x16x32_bf16 v[40:43], v[112:115], v[104:107], v[40:43]
    ds_read_b128 v[96:99], v9 offset:36864
    s_waitcnt lgkmcnt(1)
    v_mfma_f32_16x16x32_bf16 v[40:43], v[116:119], v[108:111], v[40:43]
    ds_read_b128 v[100:103], v10 offset:36864
    v_mov_b32 v197, 0
    v_mfma_f32_16x16x32_bf16 v[44:47], v[120:123], v[104:107], v[44:47]
    v_mfma_f32_16x16x32_bf16 v[44:47], v[124:127], v[108:111], v[44:47]
    v_mfma_f32_16x16x32_bf16 v[72:75], v[128:131], v[104:107], v[72:75]
    v_mov_b32_e64 v198, 0
    v_mfma_f32_16x16x32_bf16 v[72:75], v[132:135], v[108:111], v[72:75]
    v_mfma_f32_16x16x32_bf16 v[76:79], v[136:139], v[104:107], v[76:79]
    v_mov_b32 v199, 0
    v_mfma_f32_16x16x32_bf16 v[76:79], v[140:143], v[108:111], v[76:79]
    s_waitcnt lgkmcnt(1)
    v_mfma_f32_16x16x32_bf16 v[48:51], v[112:115], v[96:99], v[48:51]
    ds_read_b128 v[104:107], v9 offset:38912
    v_mov_b32 v201, v30
    s_waitcnt lgkmcnt(1)
    v_mfma_f32_16x16x32_bf16 v[48:51], v[116:119], v[100:103], v[48:51]
    ds_read_b128 v[108:111], v10 offset:38912
    v_mfma_f32_16x16x32_bf16 v[52:55], v[120:123], v[96:99], v[52:55]
    v_mfma_f32_16x16x32_bf16 v[52:55], v[124:127], v[100:103], v[52:55]
    v_permlane32_swap_b32 v201, v205
    v_mfma_f32_16x16x32_bf16 v[80:83], v[128:131], v[96:99], v[80:83]
    v_mfma_f32_16x16x32_bf16 v[80:83], v[132:135], v[100:103], v[80:83]
    v_permlane16_swap_b32 v201, v203
    v_mfma_f32_16x16x32_bf16 v[84:87], v[136:139], v[96:99], v[84:87]
    v_mfma_f32_16x16x32_bf16 v[84:87], v[140:143], v[100:103], v[84:87]
    v_permlane16_swap_b32 v205, v207
    s_waitcnt lgkmcnt(0)
    s_barrier
    s_nop 0
    v_xor_b32 v9, 0x10000, v9
    v_xor_b32 v10, 0x10000, v10
    v_xor_b32 v11, 0x10000, v11
    v_xor_b32 v12, 0x10000, v12
    v_xor_b32 v13, 0x10000, v13
    v_xor_b32 v14, 0x10000, v14
    ds_read_b64_tr_b16 v[224:225], v11 offset:16384
    ds_read_b64_tr_b16 v[226:227], v11 offset:17408
    ds_read_b128 v[96:99], v9 offset:0
    v_mfma_f32_16x16x32_bf16 v[56:59], v[112:115], v[104:107], v[56:59]
    ds_read_b64_tr_b16 v[228:229], v11 offset:24576
    ds_read_b64_tr_b16 v[230:231], v11 offset:25600
    v_mfma_f32_16x16x32_bf16 v[56:59], v[116:119], v[108:111], v[56:59]
    ds_read_b128 v[100:103], v10 offset:0
    ds_read_b64_tr_b16 v[232:233], v12 offset:16384
    ds_read_b64_tr_b16 v[144:145], v15 offset:0
    v_mfma_f32_16x16x32_bf16 v[60:63], v[120:123], v[104:107], v[60:63]
    ds_read_b64_tr_b16 v[234:235], v12 offset:17408
    ds_read_b64_tr_b16 v[236:237], v12 offset:24576
    v_mfma_f32_16x16x32_bf16 v[60:63], v[124:127], v[108:111], v[60:63]
    ds_read_b64_tr_b16 v[238:239], v12 offset:25600
    ds_read_b64_tr_b16 v[240:241], v13 offset:16384
    ds_read_b64_tr_b16 v[148:149], v16 offset:0
    v_mfma_f32_16x16x32_bf16 v[88:91], v[128:131], v[104:107], v[88:91]
    ds_read_b64_tr_b16 v[242:243], v13 offset:17408
    ds_read_b64_tr_b16 v[244:245], v13 offset:24576
    v_mfma_f32_16x16x32_bf16 v[88:91], v[132:135], v[108:111], v[88:91]
    ds_read_b64_tr_b16 v[246:247], v13 offset:25600
    ds_read_b64_tr_b16 v[248:249], v14 offset:16384
    ds_read_b64_tr_b16 v[152:153], v17 offset:0
    v_mfma_f32_16x16x32_bf16 v[92:95], v[136:139], v[104:107], v[92:95]
    ds_read_b64_tr_b16 v[250:251], v14 offset:17408
    ds_read_b64_tr_b16 v[252:253], v14 offset:24576
    v_mfma_f32_16x16x32_bf16 v[92:95], v[140:143], v[108:111], v[92:95]
    ds_read_b64_tr_b16 v[254:255], v14 offset:25600
    ds_read_b64_tr_b16 v[156:157], v18 offset:0
    s_waitcnt lgkmcnt(14)
    v_mfma_f32_16x16x32_bf16 v[32:35], v[224:227], v[96:99], v[32:35]
    ds_read_b128 v[104:107], v9 offset:2048
    v_mfma_f32_16x16x32_bf16 v[32:35], v[228:231], v[100:103], v[32:35]
    ds_read_b128 v[108:111], v10 offset:2048
    ds_read_b64_tr_b16 v[146:147], v15 offset:2048
    s_waitcnt lgkmcnt(14)
    v_mfma_f32_16x16x32_bf16 v[36:39], v[232:235], v[96:99], v[36:39]
    v_mfma_f32_16x16x32_bf16 v[36:39], v[236:239], v[100:103], v[36:39]
    ds_read_b64_tr_b16 v[150:151], v16 offset:2048
    s_waitcnt lgkmcnt(12)
    v_mfma_f32_16x16x32_bf16 v[64:67], v[240:243], v[96:99], v[64:67]
    s_waitcnt lgkmcnt(10)
    v_mfma_f32_16x16x32_bf16 v[64:67], v[244:247], v[100:103], v[64:67]
    ds_read_b64_tr_b16 v[154:155], v17 offset:2048
    s_waitcnt lgkmcnt(8)
    v_mfma_f32_16x16x32_bf16 v[68:71], v[248:251], v[96:99], v[68:71]
    s_waitcnt lgkmcnt(6)
    v_mfma_f32_16x16x32_bf16 v[68:71], v[252:255], v[100:103], v[68:71]
    ds_read_b64_tr_b16 v[158:159], v18 offset:2048
    s_waitcnt lgkmcnt(5)
    v_mfma_f32_16x16x32_bf16 v[40:43], v[224:227], v[104:107], v[40:43]
    ds_read_b128 v[96:99], v9 offset:4096
    s_waitcnt lgkmcnt(5)
    v_mfma_f32_16x16x32_bf16 v[40:43], v[228:231], v[108:111], v[40:43]
    ds_read_b128 v[100:103], v10 offset:4096
    ds_read_b64_tr_b16 v[160:161], v15 offset:4096
    v_mfma_f32_16x16x32_bf16 v[44:47], v[232:235], v[104:107], v[44:47]
    v_mfma_f32_16x16x32_bf16 v[44:47], v[236:239], v[108:111], v[44:47]
    ds_read_b64_tr_b16 v[164:165], v16 offset:4096
    v_mfma_f32_16x16x32_bf16 v[72:75], v[240:243], v[104:107], v[72:75]
    v_mfma_f32_16x16x32_bf16 v[72:75], v[244:247], v[108:111], v[72:75]
    ds_read_b64_tr_b16 v[168:169], v17 offset:4096
    v_mfma_f32_16x16x32_bf16 v[76:79], v[248:251], v[104:107], v[76:79]
    v_mfma_f32_16x16x32_bf16 v[76:79], v[252:255], v[108:111], v[76:79]
    ds_read_b64_tr_b16 v[172:173], v18 offset:4096
    s_waitcnt lgkmcnt(5)
    v_mfma_f32_16x16x32_bf16 v[48:51], v[224:227], v[96:99], v[48:51]
    ds_read_b128 v[104:107], v9 offset:6144
    s_waitcnt lgkmcnt(5)
    v_mfma_f32_16x16x32_bf16 v[48:51], v[228:231], v[100:103], v[48:51]
    ds_read_b128 v[108:111], v10 offset:6144
    ds_read_b64_tr_b16 v[162:163], v15 offset:6144
    v_mfma_f32_16x16x32_bf16 v[52:55], v[232:235], v[96:99], v[52:55]
    v_mfma_f32_16x16x32_bf16 v[52:55], v[236:239], v[100:103], v[52:55]
    ds_read_b64_tr_b16 v[166:167], v16 offset:6144
    v_mfma_f32_16x16x32_bf16 v[80:83], v[240:243], v[96:99], v[80:83]
    v_mfma_f32_16x16x32_bf16 v[80:83], v[244:247], v[100:103], v[80:83]
    ds_read_b64_tr_b16 v[170:171], v17 offset:6144
    v_mfma_f32_16x16x32_bf16 v[84:87], v[248:251], v[96:99], v[84:87]
    v_mfma_f32_16x16x32_bf16 v[84:87], v[252:255], v[100:103], v[84:87]
    ds_read_b64_tr_b16 v[174:175], v18 offset:6144
    s_waitcnt lgkmcnt(0)
    s_barrier
    ds_read_b64_tr_b16 v[112:113], v11 offset:49152
    ds_read_b64_tr_b16 v[114:115], v11 offset:50176
    ds_read_b128 v[96:99], v9 offset:32768
    v_mfma_f32_16x16x32_bf16 v[56:59], v[224:227], v[104:107], v[56:59]
    ds_read_b64_tr_b16 v[116:117], v11 offset:57344
    ds_read_b64_tr_b16 v[118:119], v11 offset:58368
    v_mfma_f32_16x16x32_bf16 v[56:59], v[228:231], v[108:111], v[56:59]
    ds_read_b128 v[100:103], v10 offset:32768
    ds_read_b64_tr_b16 v[120:121], v12 offset:49152
    v_mfma_f32_16x16x32_bf16 v[60:63], v[232:235], v[104:107], v[60:63]
    ds_read_b64_tr_b16 v[122:123], v12 offset:50176
    ds_read_b64_tr_b16 v[124:125], v12 offset:57344
    v_mfma_f32_16x16x32_bf16 v[60:63], v[236:239], v[108:111], v[60:63]
    ds_read_b64_tr_b16 v[126:127], v12 offset:58368
    ds_read_b64_tr_b16 v[128:129], v13 offset:49152
    v_mfma_f32_16x16x32_bf16 v[88:91], v[240:243], v[104:107], v[88:91]
    ds_read_b64_tr_b16 v[130:131], v13 offset:50176
    ds_read_b64_tr_b16 v[132:133], v13 offset:57344
    v_mfma_f32_16x16x32_bf16 v[88:91], v[244:247], v[108:111], v[88:91]
    ds_read_b64_tr_b16 v[134:135], v13 offset:58368
    ds_read_b64_tr_b16 v[136:137], v14 offset:49152
    v_mfma_f32_16x16x32_bf16 v[92:95], v[248:251], v[104:107], v[92:95]
    ds_read_b64_tr_b16 v[138:139], v14 offset:50176
    ds_read_b64_tr_b16 v[140:141], v14 offset:57344
    v_mfma_f32_16x16x32_bf16 v[92:95], v[252:255], v[108:111], v[92:95]
    ds_read_b64_tr_b16 v[142:143], v14 offset:58368
    s_waitcnt lgkmcnt(14)
    v_mfma_f32_16x16x32_bf16 v[32:35], v[112:115], v[96:99], v[32:35]
    ds_read_b128 v[104:107], v9 offset:34816
    s_waitcnt lgkmcnt(13)
    v_mfma_f32_16x16x32_bf16 v[32:35], v[116:119], v[100:103], v[32:35]
    ds_read_b128 v[108:111], v10 offset:34816
    s_waitcnt lgkmcnt(12)
    v_mfma_f32_16x16x32_bf16 v[36:39], v[120:123], v[96:99], v[36:39]
    s_waitcnt lgkmcnt(10)
    v_mfma_f32_16x16x32_bf16 v[36:39], v[124:127], v[100:103], v[36:39]
    s_waitcnt lgkmcnt(8)
    v_mfma_f32_16x16x32_bf16 v[64:67], v[128:131], v[96:99], v[64:67]
    s_waitcnt lgkmcnt(6)
    v_mfma_f32_16x16x32_bf16 v[64:67], v[132:135], v[100:103], v[64:67]
    s_waitcnt lgkmcnt(4)
    v_mfma_f32_16x16x32_bf16 v[68:71], v[136:139], v[96:99], v[68:71]
    s_waitcnt lgkmcnt(2)
    v_mfma_f32_16x16x32_bf16 v[68:71], v[140:143], v[100:103], v[68:71]
    buffer_load_dwordx2 v[216:217], v26, s[44:47], 0 offen sc1
    s_waitcnt lgkmcnt(1)
    v_mfma_f32_16x16x32_bf16 v[40:43], v[112:115], v[104:107], v[40:43]
    ds_read_b128 v[96:99], v9 offset:36864
    s_waitcnt lgkmcnt(1)
    v_mfma_f32_16x16x32_bf16 v[40:43], v[116:119], v[108:111], v[40:43]
    ds_read_b128 v[100:103], v10 offset:36864
    v_mfma_f32_16x16x32_bf16 v[44:47], v[120:123], v[104:107], v[44:47]
    v_mfma_f32_16x16x32_bf16 v[44:47], v[124:127], v[108:111], v[44:47]
    v_mfma_f32_16x16x32_bf16 v[72:75], v[128:131], v[104:107], v[72:75]
    v_mfma_f32_16x16x32_bf16 v[72:75], v[132:135], v[108:111], v[72:75]
    v_mfma_f32_16x16x32_bf16 v[76:79], v[136:139], v[104:107], v[76:79]
    v_mfma_f32_16x16x32_bf16 v[76:79], v[140:143], v[108:111], v[76:79]
    s_waitcnt lgkmcnt(1)
    v_mfma_f32_16x16x32_bf16 v[48:51], v[112:115], v[96:99], v[48:51]
    ds_read_b128 v[104:107], v9 offset:38912
    s_waitcnt lgkmcnt(1)
    v_mfma_f32_16x16x32_bf16 v[48:51], v[116:119], v[100:103], v[48:51]
    ds_read_b128 v[108:111], v10 offset:38912
    v_mfma_f32_16x16x32_bf16 v[52:55], v[120:123], v[96:99], v[52:55]
    v_mfma_f32_16x16x32_bf16 v[52:55], v[124:127], v[100:103], v[52:55]
    v_mfma_f32_16x16x32_bf16 v[80:83], v[128:131], v[96:99], v[80:83]
    v_mfma_f32_16x16x32_bf16 v[80:83], v[132:135], v[100:103], v[80:83]
L_hop2:
    s_cbranch_execz L_hopped
    s_nop 0
    v_mfma_f32_16x16x32_bf16 v[84:87], v[136:139], v[96:99], v[84:87]
    v_mfma_f32_16x16x32_bf16 v[84:87], v[140:143], v[100:103], v[84:87]
    buffer_load_dwordx2 v[218:219], v27, s[44:47], 0 offen sc1
    s_waitcnt lgkmcnt(0)
    s_barrier
    v_xor_b32 v9, 0x10000, v9
    v_xor_b32 v10, 0x10000, v10
    v_xor_b32 v11, 0x10000, v11
    v_xor_b32 v12, 0x10000, v12
    v_xor_b32 v13, 0x10000, v13
    v_xor_b32 v14, 0x10000, v14
    ds_read_b64_tr_b16 v[224:225], v11 offset:16384
    ds_read_b64_tr_b16 v[226:227], v11 offset:17408
    ds_read_b128 v[96:99], v9 offset:0
    v_mfma_f32_16x16x32_bf16 v[56:59], v[112:115], v[104:107], v[56:59]
    ds_read_b64_tr_b16 v[228:229], v11 offset:24576
    ds_read_b64_tr_b16 v[230:231], v11 offset:25600
    v_add_u32 v15, 65536, v15
    v_mfma_f32_16x16x32_bf16 v[56:59], v[116:119], v[108:111], v[56:59]
    ds_read_b128 v[100:103], v10 offset:0
    ds_read_b64_tr_b16 v[232:233], v12 offset:16384
    v_add_u32 v16, 65536, v16
    v_mfma_f32_16x16x32_bf16 v[60:63], v[120:123], v[104:107], v[60:63]
    ds_read_b64_tr_b16 v[234:235], v12 offset:17408
    ds_read_b64_tr_b16 v[236:237], v12 offset:24576
    v_mfma_f32_16x16x32_bf16 v[60:63], v[124:127], v[108:111], v[60:63]
    ds_read_b64_tr_b16 v[238:239], v12 offset:25600
    ds_read_b64_tr_b16 v[240:241], v13 offset:16384
    v_add_u32 v17, 65536, v17
    v_mfma_f32_16x16x32_bf16 v[88:91], v[128:131], v[104:107], v[88:91]
    ds_read_b64_tr_b16 v[242:243], v13 offset:17408
    ds_read_b64_tr_b16 v[244:245], v13 offset:24576
    v_add_u32 v18, 65536, v18
    v_mfma_f32_16x16x32_bf16 v[88:91], v[132:135], v[108:111], v[88:91]
    ds_read_b64_tr_b16 v[246:247], v13 offset:25600
    ds_read_b64_tr_b16 v[248:249], v14 offset:16384
    v_mfma_f32_16x16x32_bf16 v[92:95], v[136:139], v[104:107], v[92:95]
    ds_read_b64_tr_b16 v[250:251], v14 offset:17408
    ds_read_b64_tr_b16 v[252:253], v14 offset:24576
    ds_read_b64_tr_b16 v[176:177], v15 offset:0
    v_mfma_f32_16x16x32_bf16 v[92:95], v[140:143], v[108:111], v[92:95]
    ds_read_b64_tr_b16 v[254:255], v14 offset:25600
    ds_read_b64_tr_b16 v[180:181], v16 offset:0
    s_waitcnt lgkmcnt(14)
    v_mfma_f32_16x16x32_bf16 v[32:35], v[224:227], v[96:99], v[32:35]
    ds_read_b128 v[104:107], v9 offset:2048
    ds_read_b128 v[108:111], v10 offset:2048
    ds_read_b64_tr_b16 v[184:185], v17 offset:0
    v_mfma_f32_16x16x32_bf16 v[32:35], v[228:231], v[100:103], v[32:35]
    ds_read_b128 v[128:131], v9 offset:4096
    ds_read_b128 v[132:135], v10 offset:4096
    s_waitcnt lgkmcnt(14)
    v_mfma_f32_16x16x32_bf16 v[36:39], v[232:235], v[96:99], v[36:39]
    ds_read_b128 v[136:139], v9 offset:6144
    ds_read_b128 v[140:143], v10 offset:6144
    ds_read_b64_tr_b16 v[188:189], v18 offset:0
    v_mfma_f32_16x16x32_bf16 v[36:39], v[236:239], v[100:103], v[36:39]
    ds_read_b64_tr_b16 v[112:113], v15 offset:4096
    ds_read_b64_tr_b16 v[116:117], v16 offset:4096
    ds_read_b64_tr_b16 v[178:179], v15 offset:2048
    s_waitcnt lgkmcnt(14)
    v_mfma_f32_16x16x32_bf16 v[64:67], v[240:243], v[96:99], v[64:67]
    ds_read_b64_tr_b16 v[120:121], v17 offset:4096
    ds_read_b64_tr_b16 v[124:125], v18 offset:4096
    v_mfma_f32_16x16x32_bf16 v[64:67], v[244:247], v[100:103], v[64:67]
    ds_read_b64_tr_b16 v[114:115], v15 offset:6144
    ds_read_b64_tr_b16 v[118:119], v16 offset:6144
    ds_read_b64_tr_b16 v[182:183], v16 offset:2048
    v_mfma_f32_16x16x32_bf16 v[68:71], v[248:251], v[96:99], v[68:71]
    ds_read_b64_tr_b16 v[122:123], v17 offset:6144
    ds_read_b64_tr_b16 v[126:127], v18 offset:6144
    ds_read_b64_tr_b16 v[186:187], v17 offset:2048
    s_waitcnt lgkmcnt(14)
    v_mfma_f32_16x16x32_bf16 v[68:71], v[252:255], v[100:103], v[68:71]
    ds_read_b64_tr_b16 v[190:191], v18 offset:2048
    v_mfma_f32_16x16x32_bf16 v[40:43], v[224:227], v[104:107], v[40:43]
    v_mfma_f32_16x16x32_bf16 v[40:43], v[228:231], v[108:111], v[40:43]
    v_mfma_f32_16x16x32_bf16 v[44:47], v[232:235], v[104:107], v[44:47]
    v_mfma_f32_16x16x32_bf16 v[44:47], v[236:239], v[108:111], v[44:47]
    v_mfma_f32_16x16x32_bf16 v[72:75], v[240:243], v[104:107], v[72:75]
    s_waitcnt lgkmcnt(0)
    s_barrier
    v_mfma_f32_16x16x32_bf16 v[72:75], v[244:247], v[108:111], v[72:75]
    v_mfma_f32_16x16x32_bf16 v[76:79], v[248:251], v[104:107], v[76:79]
    s_mov_b32 s96, 0
    s_waitcnt vmcnt(0)
L_chk_22:
    v_xor_b32_e64 v25, s52, v217
    v_bitop3_b32 v25, v219, s52, v25 bitop3:0xbe
    v_cmp_ne_u32 vcc, 0, v25
    s_add_u32 s96, s96, 1
    s_nop 3
    s_cbranch_vccz L_chkd_23
    s_cmp_gt_u32 s96, 131072
    s_cbranch_scc1 L_chkd_23
    buffer_load_dwordx2 v[216:217], v26, s[44:47], 0 offen sc1
    buffer_load_dwordx2 v[218:219], v27, s[44:47], 0 offen sc1
    s_waitcnt vmcnt(0)
    s_branch L_chk_22
L_chkd_23:
    v_mfma_f32_16x16x32_bf16 v[76:79], v[252:255], v[108:111], v[76:79]
    s_mov_b32 s78, 0x01000100
    v_mfma_f32_16x16x32_bf16 v[48:51], v[224:227], v[128:131], v[48:51]
    v_perm_b32 v192, v216, v216, s78
    v_lshrrev_b32 v193, 16, v216
    v_mfma_f32_16x16x32_bf16 v[48:51], v[228:231], v[132:135], v[48:51]
    v_xor_b32 v192, 0x80008000, v192
    v_mfma_f32_16x16x32_bf16 v[52:55], v[232:235], v[128:131], v[52:55]
    v_cvt_pk_bf16_f32 v25, v218, v218
    v_and_b32 v28, 0xffff0000, v216
    v_mfma_f32_16x16x32_bf16 v[52:55], v[236:239], v[132:135], v[52:55]
    v_and_b32 v25, 0xffff0000, v25
    v_mfma_f32_16x16x32_bf16 v[80:83], v[240:243], v[128:131], v[80:83]
    v_rcp_f32 v28, v28
    v_sub_f32 v25, v218, v25
    v_mfma_f32_16x16x32_bf16 v[80:83], v[244:247], v[132:135], v[80:83]
    v_cvt_pk_bf16_f32 v200, v218, v25
    v_mfma_f32_16x16x32_bf16 v[84:87], v[248:251], v[128:131], v[84:87]
    v_mul_f32 v2, 1069066811, v28
    v_mul_f32 v6, 1069066811, v28
    v_mfma_f32_16x16x32_bf16 v[84:87], v[252:255], v[132:135], v[84:87]
    v_permlane32_swap_b32 v192, v196
    v_mfma_f32_16x16x32_bf16 v[56:59], v[224:227], v[136:139], v[56:59]
    v_permlane32_swap_b32 v193, v197
    v_permlane32_swap_b32 v200, v204
    v_mfma_f32_16x16x32_bf16 v[56:59], v[228:231], v[140:143], v[56:59]
    v_permlane32_swap_b32 v2, v6
    v_mfma_f32_16x16x32_bf16 v[60:63], v[232:235], v[136:139], v[60:63]
    v_permlane16_swap_b32 v192, v194
    v_permlane16_swap_b32 v193, v195
    v_mfma_f32_16x16x32_bf16 v[60:63], v[236:239], v[140:143], v[60:63]
    v_permlane16_swap_b32 v200, v202
    v_mfma_f32_16x16x32_bf16 v[88:91], v[240:243], v[136:139], v[88:91]
    v_mov_b32 v4, v2
    v_mov_b32 v8, v6
    v_mfma_f32_16x16x32_bf16 v[88:91], v[244:247], v[140:143], v[88:91]
    v_permlane16_swap_b32 v196, v198
    v_mfma_f32_16x16x32_bf16 v[92:95], v[248:251], v[136:139], v[92:95]
    v_permlane16_swap_b32 v197, v199
    v_permlane16_swap_b32 v204, v206
    v_mfma_f32_16x16x32_bf16 v[92:95], v[252:255], v[140:143], v[92:95]
    v_permlane16_swap_b32 v2, v4
    v_permlane16_swap_b32 v6, v8
    v_mfma_f32_16x16x16_bf16 v[32:35], v[200:201], v[192:193], v[32:35]
    v_mfma_f32_16x16x16_bf16 v[36:39], v[202:203], v[192:193], v[36:39]
    v_mfma_f32_16x16x16_bf16 v[40:43], v[200:201], v[194:195], v[40:43]
    v_mfma_f32_16x16x16_bf16 v[44:47], v[202:203], v[194:195], v[44:47]
    s_nop 4
    v_mul_f32 v208, v32, v2
    v_mul_f32 v209, v33, v2
    v_mul_f32 v210, v34, v2
    v_mul_f32 v211, v35, v2
    v_mfma_f32_16x16x16_bf16 v[48:51], v[200:201], v[196:197], v[48:51]
    v_mul_f32 v212, v36, v2
    v_mul_f32 v213, v37, v2
    v_mul_f32 v214, v38, v2
    v_mfma_f32_16x16x16_bf16 v[52:55], v[202:203], v[196:197], v[52:55]
    v_mul_f32 v215, v39, v2
    v_exp_f32 v208, v208
    v_exp_f32_e64 v209, v209
    v_mfma_f32_16x16x16_bf16 v[56:59], v[200:201], v[198:199], v[56:59]
    v_exp_f32 v210, v210
    v_exp_f32 v211, v211
    v_exp_f32 v212, v212
    v_exp_f32 v213, v213
    v_mfma_f32_16x16x16_bf16 v[60:63], v[202:203], v[198:199], v[60:63]
    v_exp_f32 v214, v214
    v_exp_f32 v215, v215
    v_fma_f32 v216, v208, 0.5, 1.0
    v_mfma_f32_16x16x16_bf16 v[64:67], v[204:205], v[192:193], v[64:67]
    v_fma_f32 v217, v209, 0.5, 1.0
    v_fma_f32 v218, v210, 0.5, 1.0
    v_fma_f32 v219, v211, 0.5, 1.0
    v_mfma_f32_16x16x16_bf16 v[68:71], v[206:207], v[192:193], v[68:71]
    v_fma_f32 v220, v212, 0.5, 1.0
    v_fma_f32 v221, v213, 0.5, 1.0
    v_fma_f32 v222, v214, 0.5, 1.0
    v_fma_f32 v223, v215, 0.5, 1.0
    v_mfma_f32_16x16x16_bf16 v[72:75], v[204:205], v[194:195], v[72:75]
    v_fma_f32 v216, v208, v216, 1.0
    v_fma_f32 v217, v209, v217, 1.0
    v_fma_f32 v218, v210, v218, 1.0
    v_mfma_f32_16x16x16_bf16 v[76:79], v[206:207], v[194:195], v[76:79]
    v_fma_f32 v219, v211, v219, 1.0
    v_fma_f32 v220, v212, v220, 1.0
    v_fma_f32 v221, v213, v221, 1.0
    v_mfma_f32_16x16x16_bf16 v[80:83], v[204:205], v[196:197], v[80:83]
    v_fma_f32 v222, v214, v222, 1.0
    v_fma_f32 v223, v215, v223, 1.0
    v_rcp_f32 v216, v216
    v_rcp_f32 v217, v217
    v_mfma_f32_16x16x16_bf16 v[84:87], v[206:207], v[196:197], v[84:87]
    v_rcp_f32 v218, v218
    v_rcp_f32 v219, v219
    v_rcp_f32 v220, v220
    v_mfma_f32_16x16x16_bf16 v[88:91], v[204:205], v[198:199], v[88:91]
    v_rcp_f32 v221, v221
    v_rcp_f32 v222, v222
    v_rcp_f32 v223, v223
    v_mfma_f32_16x16x16_bf16 v[92:95], v[206:207], v[198:199], v[92:95]
    v_fma_f32 v216, -v32, v216, v32
    v_fma_f32 v217, -v33, v217, v33
    v_fma_f32 v218, -v34, v218, v34
    v_fma_f32 v219, -v35, v219, v35
    v_fma_f32 v220, -v36, v220, v36
    v_fma_f32 v221, -v37, v221, v37
    v_fma_f32 v222, -v38, v222, v38
    v_fma_f32 v223, -v39, v223, v39
    v_cvt_pk_bf16_f32 v240, v216, v217
    v_cvt_pk_bf16_f32 v241, v218, v219
    v_cvt_pk_bf16_f32 v242, v220, v221
    v_cvt_pk_bf16_f32 v243, v222, v223
    buffer_store_dwordx4 v[240:243], v21, s[44:47], s70 offen offset:0 sc1
    v_mul_f32 v224, v40, v4
    v_mul_f32 v225, v41, v4
    v_mul_f32 v226, v42, v4
    v_mul_f32 v227, v43, v4
    v_mul_f32 v228, v44, v4
    v_mul_f32 v229, v45, v4
    v_mul_f32 v230, v46, v4
    v_mul_f32 v231, v47, v4
    v_exp_f32 v224, v224
    v_exp_f32 v225, v225
    v_exp_f32 v226, v226
    v_exp_f32 v227, v227
    v_exp_f32 v228, v228
    v_exp_f32 v229, v229
    v_exp_f32 v230, v230
    v_exp_f32 v231, v231
    v_fma_f32 v232, v224, 0.5, 1.0
    v_fma_f32 v233, v225, 0.5, 1.0
    v_fma_f32 v234, v226, 0.5, 1.0
    v_fma_f32 v235, v227, 0.5, 1.0
    v_fma_f32 v236, v228, 0.5, 1.0
    v_fma_f32 v237, v229, 0.5, 1.0
    v_fma_f32 v238, v230, 0.5, 1.0
    v_fma_f32 v239, v231, 0.5, 1.0
    v_fma_f32 v232, v224, v232, 1.0
    v_fma_f32 v233, v225, v233, 1.0
    v_fma_f32 v234, v226, v234, 1.0
    v_fma_f32 v235, v227, v235, 1.0
    v_fma_f32 v236, v228, v236, 1.0
    v_fma_f32 v237, v229, v237, 1.0
    v_fma_f32 v238, v230, v238, 1.0
    v_fma_f32 v239, v231, v239, 1.0
    v_rcp_f32 v232, v232
    v_rcp_f32 v233, v233
    v_rcp_f32 v234, v234
    v_rcp_f32 v235, v235
    v_rcp_f32 v236, v236
    v_rcp_f32 v237, v237
    v_rcp_f32 v238, v238
    v_rcp_f32 v239, v239
    v_fma_f32 v232, -v40, v232, v40
    v_fma_f32 v233, -v41, v233, v41
    v_fma_f32 v234, -v42, v234, v42
    v_fma_f32 v235, -v43, v235, v43
    v_fma_f32 v236, -v44, v236, v44
    v_fma_f32 v237, -v45, v237, v45
    v_fma_f32 v238, -v46, v238, v46
    v_fma_f32 v239, -v47, v239, v47
    v_cvt_pk_bf16_f32 v244, v232, v233
    v_cvt_pk_bf16_f32 v245, v234, v235
    v_cvt_pk_bf16_f32 v246, v236, v237
    v_cvt_pk_bf16_f32 v247, v238, v239
    buffer_store_dwordx4 v[244:247], v21, s[44:47], s70 offen offset:1024 sc1
    v_mul_f32 v208, v48, v6
    v_mul_f32 v209, v49, v6
    v_mul_f32 v210, v50, v6
    v_mul_f32 v211, v51, v6
    v_mul_f32 v212, v52, v6
    v_mul_f32 v213, v53, v6
    v_mul_f32 v214, v54, v6
    v_mul_f32 v215, v55, v6
    v_exp_f32 v208, v208
    v_exp_f32 v209, v209
    v_exp_f32 v210, v210
    v_exp_f32 v211, v211
    v_exp_f32 v212, v212
    v_exp_f32 v213, v213
    v_exp_f32 v214, v214
    v_exp_f32 v215, v215
    v_fma_f32 v216, v208, 0.5, 1.0
    v_fma_f32 v217, v209, 0.5, 1.0
    v_fma_f32 v218, v210, 0.5, 1.0
    v_fma_f32 v219, v211, 0.5, 1.0
    v_fma_f32 v220, v212, 0.5, 1.0
    v_fma_f32 v221, v213, 0.5, 1.0
    v_fma_f32 v222, v214, 0.5, 1.0
    v_fma_f32 v223, v215, 0.5, 1.0
    v_fma_f32 v216, v208, v216, 1.0
    v_fma_f32 v217, v209, v217, 1.0
    v_fma_f32 v218, v210, v218, 1.0
    v_fma_f32 v219, v211, v219, 1.0
    v_fma_f32 v220, v212, v220, 1.0
    v_fma_f32 v221, v213, v221, 1.0
    v_fma_f32 v222, v214, v222, 1.0
    v_fma_f32 v223, v215, v223, 1.0
    v_rcp_f32 v216, v216
    v_rcp_f32 v217, v217
    v_rcp_f32 v218, v218
    v_rcp_f32 v219, v219
    v_rcp_f32 v220, v220
    v_rcp_f32 v221, v221
    v_rcp_f32 v222, v222
    v_rcp_f32 v223, v223
    v_fma_f32 v216, -v48, v216, v48
    v_fma_f32 v217, -v49, v217, v49
    v_fma_f32 v218, -v50, v218, v50
    v_fma_f32 v219, -v51, v219, v51
    v_fma_f32 v220, -v52, v220, v52
    v_fma_f32 v221, -v53, v221, v53
    v_fma_f32 v222, -v54, v222, v54
    v_fma_f32 v223, -v55, v223, v55
    v_cvt_pk_bf16_f32 v248, v216, v217
    v_cvt_pk_bf16_f32 v249, v218, v219
    v_cvt_pk_bf16_f32 v250, v220, v221
    v_cvt_pk_bf16_f32 v251, v222, v223
    buffer_store_dwordx4 v[248:251], v21, s[44:47], s70 offen offset:2048 sc1
    v_mul_f32 v224, v56, v8
    v_mul_f32 v225, v57, v8
    v_mul_f32 v226, v58, v8
    v_mul_f32 v227, v59, v8
    v_mul_f32 v228, v60, v8
    v_mul_f32 v229, v61, v8
    v_mul_f32 v230, v62, v8
    v_mul_f32 v231, v63, v8
    v_exp_f32 v224, v224
    v_exp_f32 v225, v225
    v_exp_f32 v226, v226
    v_exp_f32 v227, v227
    v_exp_f32 v228, v228
    v_exp_f32 v229, v229
    v_exp_f32 v230, v230
    v_exp_f32 v231, v231
    v_fma_f32 v232, v224, 0.5, 1.0
    v_fma_f32 v233, v225, 0.5, 1.0
    v_fma_f32 v234, v226, 0.5, 1.0
    v_fma_f32 v235, v227, 0.5, 1.0
    v_fma_f32 v236, v228, 0.5, 1.0
    v_fma_f32 v237, v229, 0.5, 1.0
    v_fma_f32 v238, v230, 0.5, 1.0
    v_fma_f32 v239, v231, 0.5, 1.0
    v_fma_f32 v232, v224, v232, 1.0
    v_fma_f32 v233, v225, v233, 1.0
    v_fma_f32 v234, v226, v234, 1.0
    v_fma_f32 v235, v227, v235, 1.0
    v_fma_f32 v236, v228, v236, 1.0
    v_fma_f32 v237, v229, v237, 1.0
    v_fma_f32 v238, v230, v238, 1.0
    v_fma_f32 v239, v231, v239, 1.0
    v_rcp_f32 v232, v232
    v_rcp_f32 v233, v233
    v_rcp_f32 v234, v234
    v_rcp_f32 v235, v235
    v_rcp_f32 v236, v236
    v_rcp_f32 v237, v237
    v_rcp_f32 v238, v238
    v_rcp_f32 v239, v239
    v_fma_f32 v232, -v56, v232, v56
    v_fma_f32 v233, -v57, v233, v57
    v_fma_f32 v234, -v58, v234, v58
    v_fma_f32 v235, -v59, v235, v59
    v_fma_f32 v236, -v60, v236, v60
    v_fma_f32 v237, -v61, v237, v61
    v_fma_f32 v238, -v62, v238, v62
    v_fma_f32 v239, -v63, v239, v63
    v_cvt_pk_bf16_f32 v252, v232, v233
    v_cvt_pk_bf16_f32 v253, v234, v235
    v_cvt_pk_bf16_f32 v254, v236, v237
    v_cvt_pk_bf16_f32 v255, v238, v239
    buffer_store_dwordx4 v[252:255], v21, s[44:47], s70 offen offset:3072 sc1
    s_add_u32 s70, s70, 3670016
    v_mul_f32 v208, v64, v2
    v_mul_f32 v209, v65, v2
    v_mul_f32 v210, v66, v2
    v_mul_f32 v211, v67, v2
    v_mul_f32 v212, v68, v2
    v_mul_f32 v213, v69, v2
    v_mul_f32 v214, v70, v2
    v_mul_f32 v215, v71, v2
    v_exp_f32 v208, v208
    v_exp_f32 v209, v209
    v_exp_f32 v210, v210
    v_exp_f32 v211, v211
    v_exp_f32 v212, v212
    v_exp_f32 v213, v213
    v_exp_f32 v214, v214
    v_exp_f32 v215, v215
    v_fma_f32 v216, v208, 0.5, 1.0
    v_fma_f32 v217, v209, 0.5, 1.0
    v_fma_f32 v218, v210, 0.5, 1.0
    v_fma_f32 v219, v211, 0.5, 1.0
    v_fma_f32 v220, v212, 0.5, 1.0
    v_fma_f32 v221, v213, 0.5, 1.0
    v_fma_f32 v222, v214, 0.5, 1.0
    v_fma_f32 v223, v215, 0.5, 1.0
    v_fma_f32 v216, v208, v216, 1.0
    v_fma_f32 v217, v209, v217, 1.0
    v_fma_f32 v218, v210, v218, 1.0
    v_fma_f32 v219, v211, v219, 1.0
    v_fma_f32 v220, v212, v220, 1.0
    v_fma_f32 v221, v213, v221, 1.0
    v_fma_f32 v222, v214, v222, 1.0
    v_fma_f32 v223, v215, v223, 1.0
    v_rcp_f32 v216, v216
    v_rcp_f32 v217, v217
    v_rcp_f32 v218, v218
    v_rcp_f32 v219, v219
    v_rcp_f32 v220, v220
    v_rcp_f32 v221, v221
    v_rcp_f32 v222, v222
    v_rcp_f32 v223, v223
    v_fma_f32 v216, -v64, v216, v64
    v_fma_f32 v217, -v65, v217, v65
    v_fma_f32 v218, -v66, v218, v66
    v_fma_f32 v219, -v67, v219, v67
    v_fma_f32 v220, -v68, v220, v68
    v_fma_f32 v221, -v69, v221, v69
    v_fma_f32 v222, -v70, v222, v70
    v_fma_f32 v223, -v71, v223, v71
    v_cvt_pk_bf16_f32 v240, v216, v217
    v_cvt_pk_bf16_f32 v241, v218, v219
    v_cvt_pk_bf16_f32 v242, v220, v221
    v_cvt_pk_bf16_f32 v243, v222, v223
    buffer_store_dwordx4 v[240:243], v21, s[44:47], s70 offen offset:0 sc1
    v_mul_f32 v224, v72, v4
    v_mul_f32 v225, v73, v4
    v_mul_f32 v226, v74, v4
    v_mul_f32 v227, v75, v4
    v_mul_f32 v228, v76, v4
    v_mul_f32 v229, v77, v4
    v_mul_f32 v230, v78, v4
    v_mul_f32 v231, v79, v4
    v_exp_f32 v224, v224
    v_exp_f32 v225, v225
    v_exp_f32 v226, v226
    v_exp_f32 v227, v227
    v_exp_f32 v228, v228
    v_exp_f32 v229, v229
    v_exp_f32 v230, v230
    v_exp_f32 v231, v231
    v_fma_f32 v232, v224, 0.5, 1.0
    v_fma_f32 v233, v225, 0.5, 1.0
    v_fma_f32 v234, v226, 0.5, 1.0
    v_fma_f32 v235, v227, 0.5, 1.0
    v_fma_f32 v236, v228, 0.5, 1.0
    v_fma_f32 v237, v229, 0.5, 1.0
    v_fma_f32 v238, v230, 0.5, 1.0
    v_fma_f32 v239, v231, 0.5, 1.0
    v_fma_f32 v232, v224, v232, 1.0
    v_fma_f32 v233, v225, v233, 1.0
    v_fma_f32 v234, v226, v234, 1.0
    v_fma_f32 v235, v227, v235, 1.0
    v_fma_f32 v236, v228, v236, 1.0
    v_fma_f32 v237, v229, v237, 1.0
    v_fma_f32 v238, v230, v238, 1.0
    v_fma_f32 v239, v231, v239, 1.0
    v_rcp_f32 v232, v232
    v_rcp_f32 v233, v233
    v_rcp_f32 v234, v234
    v_rcp_f32 v235, v235
    v_rcp_f32 v236, v236
    v_rcp_f32 v237, v237
    v_rcp_f32 v238, v238
    v_rcp_f32 v239, v239
    v_fma_f32 v232, -v72, v232, v72
    v_fma_f32 v233, -v73, v233, v73
    v_fma_f32 v234, -v74, v234, v74
    v_fma_f32 v235, -v75, v235, v75
    v_fma_f32 v236, -v76, v236, v76
    v_fma_f32 v237, -v77, v237, v77
    v_fma_f32 v238, -v78, v238, v78
    v_fma_f32 v239, -v79, v239, v79
    v_cvt_pk_bf16_f32 v244, v232, v233
    v_cvt_pk_bf16_f32 v245, v234, v235
    v_cvt_pk_bf16_f32 v246, v236, v237
    v_cvt_pk_bf16_f32 v247, v238, v239
    buffer_store_dwordx4 v[244:247], v21, s[44:47], s70 offen offset:1024 sc1
    v_mul_f32 v208, v80, v6
    v_mul_f32 v209, v81, v6
    v_mul_f32 v210, v82, v6
    v_mul_f32 v211, v83, v6
    v_mul_f32 v212, v84, v6
    v_mul_f32 v213, v85, v6
    v_mul_f32 v214, v86, v6
    v_mul_f32 v215, v87, v6
    v_exp_f32 v208, v208
    v_exp_f32 v209, v209
    v_exp_f32 v210, v210
    v_exp_f32 v211, v211
    v_exp_f32 v212, v212
    v_exp_f32 v213, v213
    v_exp_f32 v214, v214
    v_exp_f32 v215, v215
    v_fma_f32 v216, v208, 0.5, 1.0
    v_fma_f32 v217, v209, 0.5, 1.0
    v_fma_f32 v218, v210, 0.5, 1.0
    v_fma_f32 v219, v211, 0.5, 1.0
    v_fma_f32 v220, v212, 0.5, 1.0
    v_fma_f32 v221, v213, 0.5, 1.0
    v_fma_f32 v222, v214, 0.5, 1.0
    v_fma_f32 v223, v215, 0.5, 1.0
    v_fma_f32 v216, v208, v216, 1.0
    v_fma_f32 v217, v209, v217, 1.0
    v_fma_f32 v218, v210, v218, 1.0
    v_fma_f32 v219, v211, v219, 1.0
    v_fma_f32 v220, v212, v220, 1.0
    v_fma_f32 v221, v213, v221, 1.0
    v_fma_f32 v222, v214, v222, 1.0
    v_fma_f32 v223, v215, v223, 1.0
    v_rcp_f32 v216, v216
    v_rcp_f32 v217, v217
    v_rcp_f32 v218, v218
    v_rcp_f32 v219, v219
    v_rcp_f32 v220, v220
    v_rcp_f32 v221, v221
    v_rcp_f32 v222, v222
    v_rcp_f32 v223, v223
    v_fma_f32 v216, -v80, v216, v80
    v_fma_f32 v217, -v81, v217, v81
    v_fma_f32 v218, -v82, v218, v82
    v_fma_f32 v219, -v83, v219, v83
    v_fma_f32 v220, -v84, v220, v84
    v_fma_f32 v221, -v85, v221, v85
    v_fma_f32 v222, -v86, v222, v86
    v_fma_f32 v223, -v87, v223, v87
    v_cvt_pk_bf16_f32 v248, v216, v217
    v_cvt_pk_bf16_f32 v249, v218, v219
    v_cvt_pk_bf16_f32 v250, v220, v221
    v_cvt_pk_bf16_f32 v251, v222, v223
    buffer_store_dwordx4 v[248:251], v21, s[44:47], s70 offen offset:2048 sc1
    v_mul_f32 v224, v88, v8
    v_mul_f32 v225, v89, v8
    v_mul_f32 v226, v90, v8
    v_mul_f32 v227, v91, v8
    v_mul_f32 v228, v92, v8
    v_mul_f32 v229, v93, v8
    v_mul_f32 v230, v94, v8
    v_mul_f32 v231, v95, v8
    v_exp_f32 v224, v224
    v_exp_f32 v225, v225
    v_exp_f32 v226, v226
    v_exp_f32 v227, v227
    v_exp_f32 v228, v228
    v_exp_f32 v229, v229
    v_exp_f32 v230, v230
    v_exp_f32 v231, v231
    v_fma_f32 v232, v224, 0.5, 1.0
    v_fma_f32 v233, v225, 0.5, 1.0
    v_fma_f32 v234, v226, 0.5, 1.0
    v_fma_f32 v235, v227, 0.5, 1.0
    v_fma_f32 v236, v228, 0.5, 1.0
    v_fma_f32 v237, v229, 0.5, 1.0
    v_fma_f32 v238, v230, 0.5, 1.0
    v_fma_f32 v239, v231, 0.5, 1.0
    v_fma_f32 v232, v224, v232, 1.0
    v_fma_f32 v233, v225, v233, 1.0
    v_fma_f32 v234, v226, v234, 1.0
    v_fma_f32 v235, v227, v235, 1.0
    v_fma_f32 v236, v228, v236, 1.0
    v_fma_f32 v237, v229, v237, 1.0
    v_fma_f32 v238, v230, v238, 1.0
    v_fma_f32 v239, v231, v239, 1.0
    v_rcp_f32 v232, v232
    v_rcp_f32 v233, v233
    v_rcp_f32 v234, v234
    v_rcp_f32 v235, v235
    v_rcp_f32 v236, v236
    v_rcp_f32 v237, v237
    v_rcp_f32 v238, v238
    v_rcp_f32 v239, v239
    v_fma_f32 v232, -v88, v232, v88
    v_fma_f32 v233, -v89, v233, v89
    v_fma_f32 v234, -v90, v234, v90
    v_fma_f32 v235, -v91, v235, v91
    v_fma_f32 v236, -v92, v236, v92
    v_fma_f32 v237, -v93, v237, v93
    v_fma_f32 v238, -v94, v238, v94
    v_fma_f32 v239, -v95, v239, v95
    v_cvt_pk_bf16_f32 v252, v232, v233
    v_cvt_pk_bf16_f32 v253, v234, v235
    v_cvt_pk_bf16_f32 v254, v236, v237
    v_cvt_pk_bf16_f32 v255, v238, v239
    buffer_store_dwordx4 v[252:255], v21, s[44:47], s70 offen offset:3072 sc1
    s_setprio 2
    s_load_dwordx2 s[36:37], s[0:1], 0
    s_load_dwordx2 s[64:65], s[0:1], 104
    s_mov_b32 s38, 1835008
    s_mov_b32 s66, 1835008
    s_mov_b32 s67, 0x20000
    s_mov_b32 s96, 0
L_spin_24:
    ds_read_b32 v25, v29 offset:64
    s_add_u32 s96, s96, 1
    s_cmp_gt_u32 s96, 1048576
    s_waitcnt lgkmcnt(0)
    v_cmp_ne_u32 vcc, s52, v25
    s_cbranch_scc1 L_spun_25
    s_nop 3
    s_cbranch_vccnz L_spin_24
L_spun_25:
    ds_read_b64_tr_b16 v[128:129], v15 offset:32768
    ds_read_b64_tr_b16 v[132:133], v16 offset:32768
    ds_read_b64_tr_b16 v[136:137], v17 offset:32768
    ds_read_b64_tr_b16 v[140:141], v18 offset:32768
    ds_read_b64_tr_b16 v[130:131], v15 offset:34816
    ds_read_b64_tr_b16 v[134:135], v16 offset:34816
    ds_read_b64_tr_b16 v[138:139], v17 offset:34816
    ds_read_b64_tr_b16 v[142:143], v18 offset:34816
    ds_read_b64_tr_b16 v[96:97], v15 offset:36864
    ds_read_b64_tr_b16 v[100:101], v16 offset:36864
    ds_read_b64_tr_b16 v[104:105], v17 offset:36864
    ds_read_b64_tr_b16 v[108:109], v18 offset:36864
    ds_read_b64_tr_b16 v[98:99], v15 offset:38912
    ds_read_b64_tr_b16 v[102:103], v16 offset:38912
    ds_read_b64_tr_b16 v[106:107], v17 offset:38912
    ds_read_b64_tr_b16 v[110:111], v18 offset:38912
    s_add_u32 m0, s73, 0
    s_add_u32 s76, s75, 229376
    buffer_load_dwordx4 v19, s[40:43], s76 offen lds
    buffer_load_dwordx4 v20, s[40:43], s76 offen offset:1024 lds
    s_add_u32 m0, s73, 2048
    s_add_u32 s76, s75, 243712
    buffer_load_dwordx4 v19, s[40:43], s76 offen lds
    buffer_load_dwordx4 v20, s[40:43], s76 offen offset:1024 lds
    s_add_u32 m0, s73, 4096
    s_add_u32 s76, s75, 258048
    buffer_load_dwordx4 v19, s[40:43], s76 offen lds
    buffer_load_dwordx4 v20, s[40:43], s76 offen offset:1024 lds
    s_add_u32 m0, s73, 6144
    s_add_u32 s76, s75, 272384
    buffer_load_dwordx4 v19, s[40:43], s76 offen lds
L_hop3:
    s_cbranch_execz L_hopped
    buffer_load_dwordx4 v20, s[40:43], s76 offen offset:1024 lds
    s_waitcnt lgkmcnt(0)
    s_add_u32 s62, s71, 1536
    s_waitcnt vmcnt(8)
    s_atomic_swap s52, s[44:45], s62
    s_add_u32 m0, s73, 32768
    s_add_u32 s76, s75, 286720
    buffer_load_dwordx4 v19, s[40:43], s76 offen lds
    buffer_load_dwordx4 v20, s[40:43], s76 offen offset:1024 lds
    s_add_u32 m0, s73, 34816
    s_add_u32 s76, s75, 301056
    buffer_load_dwordx4 v19, s[40:43], s76 offen lds
    buffer_load_dwordx4 v20, s[40:43], s76 offen offset:1024 lds
    s_add_u32 m0, s73, 36864
    s_add_u32 s76, s75, 315392
    buffer_load_dwordx4 v19, s[40:43], s76 offen lds
    buffer_load_dwordx4 v20, s[40:43], s76 offen offset:1024 lds
    s_add_u32 m0, s73, 38912
    s_add_u32 s76, s75, 329728
    buffer_load_dwordx4 v19, s[40:43], s76 offen lds
    buffer_load_dwordx4 v20, s[40:43], s76 offen offset:1024 lds
    s_mul_i32 s63, s54, 4096
    s_add_u32 s63, s63, 33792
    s_sub_u32 s88, s63, s73
    s_sub_u32 s89, 65536, s88
    v_and_b32 v14, 3, v0
    v_lshlrev_b32 v14, 2, v14
    v_add_u32 v14, 64512, v14
    s_mov_b32 s96, 0
L_spin_26:
    ds_read_b32 v25, v14 offset:16
    s_add_u32 s96, s96, 1
    s_cmp_gt_u32 s96, 1048576
    s_waitcnt lgkmcnt(0)
    v_cmp_ne_u32 vcc, s52, v25
    s_cbranch_scc1 L_spun_27
    s_nop 3
    s_cbranch_vccnz L_spin_26
L_spun_27:
    s_add_u32 m0, s63, 0
    s_add_u32 s76, s75, 344064
    buffer_load_dwordx4 v19, s[40:43], s76 offen lds
    buffer_load_dwordx4 v20, s[40:43], s76 offen offset:1024 lds
    s_add_u32 m0, s63, 2048
    s_add_u32 s76, s75, 358400
    buffer_load_dwordx4 v19, s[40:43], s76 offen lds
    buffer_load_dwordx4 v20, s[40:43], s76 offen offset:1024 lds
    s_add_u32 s72, s72, 1536
    s_buffer_load_dwordx8 s[80:87], s[44:47], s72 glc
    s_mov_b32 s96, 0
L_chk_28:
    s_waitcnt lgkmcnt(0)
    s_cmp_eq_u64 s[80:81], s[52:53]
    s_cbranch_scc0 L_retry_29
    s_cmp_eq_u64 s[82:83], s[52:53]
    s_cbranch_scc0 L_retry_29
    s_cmp_eq_u64 s[84:85], s[52:53]
    s_cbranch_scc0 L_retry_29
    s_cmp_eq_u32 s86, s52
    s_cbranch_scc1 L_chkd_30
L_retry_29:
    s_buffer_load_dwordx8 s[80:87], s[44:47], s72 glc
    s_add_u32 s96, s96, 1
    s_cmp_le_u32 s96, 131072
    s_cbranch_scc1 L_chk_28
    s_waitcnt lgkmcnt(0)
L_chkd_30:
    s_add_u32 s79, s74, 0
    buffer_load_dwordx4 v[192:195], v21, s[44:47], s79 offen offset:0 sc1
    buffer_load_dwordx4 v[196:199], v21, s[44:47], s79 offen offset:1024 sc1
    buffer_load_dwordx4 v[200:203], v21, s[44:47], s79 offen offset:2048 sc1
    buffer_load_dwordx4 v[204:207], v21, s[44:47], s79 offen offset:3072 sc1
    s_add_u32 s79, s74, 3670016
    buffer_load_dwordx4 v[208:211], v21, s[44:47], s79 offen offset:0 sc1
    buffer_load_dwordx4 v[212:215], v21, s[44:47], s79 offen offset:1024 sc1
    buffer_load_dwordx4 v[216:219], v21, s[44:47], s79 offen offset:2048 sc1
    buffer_load_dwordx4 v[220:223], v21, s[44:47], s79 offen offset:3072 sc1
    s_add_u32 s79, s74, 4096
    buffer_load_dwordx4 v[224:227], v21, s[44:47], s79 offen offset:0 sc1
    buffer_load_dwordx4 v[228:231], v21, s[44:47], s79 offen offset:1024 sc1
    buffer_load_dwordx4 v[232:235], v21, s[44:47], s79 offen offset:2048 sc1
    buffer_load_dwordx4 v[236:239], v21, s[44:47], s79 offen offset:3072 sc1
    s_add_u32 s79, s74, 3674112
    buffer_load_dwordx4 v[240:243], v21, s[44:47], s79 offen offset:0 sc1
    buffer_load_dwordx4 v[244:247], v21, s[44:47], s79 offen offset:1024 sc1
    buffer_load_dwordx4 v[248:251], v21, s[44:47], s79 offen offset:2048 sc1
    buffer_load_dwordx4 v[252:255], v21, s[44:47], s79 offen offset:3072 sc1
    s_setprio 0
    s_waitcnt vmcnt(15)
    v_mfma_f32_16x16x32_bf16 v[32:35], v[144:147], v[192:195], 0
    v_mfma_f32_16x16x32_bf16 v[36:39], v[148:151], v[192:195], 0
    v_mfma_f32_16x16x32_bf16 v[40:43], v[152:155], v[192:195], 0
    v_mfma_f32_16x16x32_bf16 v[44:47], v[156:159], v[192:195], 0
    s_waitcnt vmcnt(14)
    v_mfma_f32_16x16x32_bf16 v[48:51], v[144:147], v[196:199], 0
    v_mfma_f32_16x16x32_bf16 v[52:55], v[148:151], v[196:199], 0
    v_mfma_f32_16x16x32_bf16 v[56:59], v[152:155], v[196:199], 0
    v_mfma_f32_16x16x32_bf16 v[60:63], v[156:159], v[196:199], 0
    s_waitcnt vmcnt(13)
    v_mfma_f32_16x16x32_bf16 v[64:67], v[144:147], v[200:203], 0
    s_add_u32 s79, s74, 8192
    buffer_load_dwordx4 v[192:195], v21, s[44:47], s79 offen offset:0 sc1
    buffer_load_dwordx4 v[196:199], v21, s[44:47], s79 offen offset:1024 sc1
    v_bfe_u32 v25, v0, 2, 1
    v_lshrrev_b32 v26, 3, v0
    v_mfma_f32_16x16x32_bf16 v[68:71], v[148:151], v[200:203], 0
    v_and_b32_e64 v27, 3, v0
    v_lshl_add_u32 v28, v25, 4, v26
    v_mfma_f32_16x16x32_bf16 v[72:75], v[152:155], v[200:203], 0
    v_mul_u32_u24 v5, 896, v28
    v_lshl_add_u32 v5, v27, 4, v5
    v_mfma_f32_16x16x32_bf16 v[76:79], v[156:159], v[200:203], 0
    v_lshlrev_b32 v13, 3, v28
    v_xor_b32 v10, s69, v25
    s_waitcnt vmcnt(14)
    v_mfma_f32_16x16x32_bf16 v[80:83], v[144:147], v[204:207], 0
    v_lshlrev_b32 v10, 3, v10
    v_lshl_add_u32 v10, v27, 1, v10
    v_mfma_f32_16x16x32_bf16 v[84:87], v[148:151], v[204:207], 0
    v_xor_b32 v10, v10, v26
    s_lshl3_add_u32 s62, s68, 384
    v_add_u32 v28, s62, v28
    v_mfma_f32_16x16x32_bf16 v[88:91], v[152:155], v[204:207], 0
    v_lshlrev_b32 v28, 8, v28
    v_lshl_add_u32 v10, v10, 4, v28
    v_xor_b32 v11, 16, v10
    v_mfma_f32_16x16x32_bf16 v[92:95], v[156:159], v[204:207], 0
    s_waitcnt vmcnt(13)
    v_mfma_f32_16x16x32_bf16 v[32:35], v[160:163], v[208:211], v[32:35]
    buffer_load_dwordx4 v[200:203], v21, s[44:47], s79 offen offset:2048 sc1
    v_mfma_f32_16x16x32_bf16 v[36:39], v[164:167], v[208:211], v[36:39]
    buffer_load_dwordx4 v[204:207], v21, s[44:47], s79 offen offset:3072 sc1
    v_mfma_f32_16x16x32_bf16 v[40:43], v[168:171], v[208:211], v[40:43]
    s_mul_i32 s62, s54, 2304
    s_add_u32 s62, s62, 56448
    v_mul_u32_u24 v12, 288, v27
    v_mfma_f32_16x16x32_bf16 v[44:47], v[172:175], v[208:211], v[44:47]
    s_waitcnt vmcnt(14)
    v_mfma_f32_16x16x32_bf16 v[48:51], v[160:163], v[212:215], v[48:51]
    v_and_b32_e64 v28, 60, v0
    v_mfma_f32_16x16x32_bf16 v[52:55], v[164:167], v[212:215], v[52:55]
    v_add3_u32 v12, v12, v28, s62
    v_mfma_f32_16x16x32_bf16 v[56:59], v[168:171], v[212:215], v[56:59]
    s_lshl3_add_u32 s70, s60, s68
    s_add_u32 s70, s70, 4
    s_lshl_b32 s78, s70, 6
    s_add_u32 s78, s78, 65536
    s_mul_i32 s70, s70, 7168
    s_lshl1_add_u32 s62, s61, s69
    s_lshl_b32 s62, s62, 6
    s_add_u32 s70, s70, s62
    v_mfma_f32_16x16x32_bf16 v[60:63], v[172:175], v[212:215], v[60:63]
    s_waitcnt vmcnt(13)
    v_mfma_f32_16x16x32_bf16 v[64:67], v[160:163], v[216:219], v[64:67]
    s_add_u32 s79, s74, 3678208
    buffer_load_dwordx4 v[208:211], v21, s[44:47], s79 offen offset:0 sc1
    buffer_load_dwordx4 v[212:215], v21, s[44:47], s79 offen offset:1024 sc1
    v_mfma_f32_16x16x32_bf16 v[68:71], v[164:167], v[216:219], v[68:71]
    v_lshrrev_b32 v25, 4, v0
    v_and_b32 v26, 7, v0
    v_mfma_f32_16x16x32_bf16 v[72:75], v[168:171], v[216:219], v[72:75]
    v_xor_b32 v25, v25, v26
    v_mfma_f32_16x16x32_bf16 v[76:79], v[172:175], v[216:219], v[76:79]
    v_and_b32 v26, 15, v0
    s_waitcnt vmcnt(14)
    v_mfma_f32_16x16x32_bf16 v[80:83], v[160:163], v[220:223], v[80:83]
    v_lshl_add_u32 v25, v26, 4, v25
    v_lshl_add_u32 v1, v25, 4, s73
    v_mfma_f32_16x16x32_bf16 v[84:87], v[164:167], v[220:223], v[84:87]
    v_xor_b32_e64 v2, 64, v1
    v_mfma_f32_16x16x32_bf16 v[88:91], v[168:171], v[220:223], v[88:91]
    v_xor_b32 v3, 128, v1
    v_xor_b32 v4, 192, v1
    v_mfma_f32_16x16x32_bf16 v[92:95], v[172:175], v[220:223], v[92:95]
    s_waitcnt vmcnt(13)
    v_mfma_f32_16x16x32_bf16 v[32:35], v[176:179], v[224:227], v[32:35]
    v_mfma_f32_16x16x32_bf16 v[36:39], v[180:183], v[224:227], v[36:39]
    v_mfma_f32_16x16x32_bf16 v[40:43], v[184:187], v[224:227], v[40:43]
    buffer_load_dwordx4 v[216:219], v21, s[44:47], s79 offen offset:2048 sc1
    v_mfma_f32_16x16x32_bf16 v[44:47], v[188:191], v[224:227], v[44:47]
    s_waitcnt vmcnt(13)
    v_mfma_f32_16x16x32_bf16 v[48:51], v[176:179], v[228:231], v[48:51]
    v_mfma_f32_16x16x32_bf16 v[52:55], v[180:183], v[228:231], v[52:55]
    v_mfma_f32_16x16x32_bf16 v[56:59], v[184:187], v[228:231], v[56:59]
    buffer_load_dwordx4 v[220:223], v21, s[44:47], s79 offen offset:3072 sc1
    v_mfma_f32_16x16x32_bf16 v[60:63], v[188:191], v[228:231], v[60:63]
    s_waitcnt vmcnt(13)
    v_mfma_f32_16x16x32_bf16 v[64:67], v[176:179], v[232:235], v[64:67]
    v_mfma_f32_16x16x32_bf16 v[68:71], v[180:183], v[232:235], v[68:71]
    v_mfma_f32_16x16x32_bf16 v[72:75], v[184:187], v[232:235], v[72:75]
    s_add_u32 s79, s74, 12288
    buffer_load_dwordx4 v[224:227], v21, s[44:47], s79 offen offset:0 sc1
    v_mfma_f32_16x16x32_bf16 v[76:79], v[188:191], v[232:235], v[76:79]
    s_waitcnt vmcnt(13)
    v_mfma_f32_16x16x32_bf16 v[80:83], v[176:179], v[236:239], v[80:83]
    v_mfma_f32_16x16x32_bf16 v[84:87], v[180:183], v[236:239], v[84:87]
    v_mfma_f32_16x16x32_bf16 v[88:91], v[184:187], v[236:239], v[88:91]
    buffer_load_dwordx4 v[228:231], v21, s[44:47], s79 offen offset:1024 sc1
    v_mfma_f32_16x16x32_bf16 v[92:95], v[188:191], v[236:239], v[92:95]
    s_waitcnt vmcnt(13)
    v_mfma_f32_16x16x32_bf16 v[32:35], v[112:115], v[240:243], v[32:35]
    v_mfma_f32_16x16x32_bf16 v[36:39], v[116:119], v[240:243], v[36:39]
    v_mfma_f32_16x16x32_bf16 v[40:43], v[120:123], v[240:243], v[40:43]
    buffer_load_dwordx4 v[232:235], v21, s[44:47], s79 offen offset:2048 sc1
    v_mfma_f32_16x16x32_bf16 v[44:47], v[124:127], v[240:243], v[44:47]
    s_waitcnt vmcnt(13)
    v_mfma_f32_16x16x32_bf16 v[48:51], v[112:115], v[244:247], v[48:51]
    v_mfma_f32_16x16x32_bf16 v[52:55], v[116:119], v[244:247], v[52:55]
    v_mfma_f32_16x16x32_bf16 v[56:59], v[120:123], v[244:247], v[56:59]
    buffer_load_dwordx4 v[236:239], v21, s[44:47], s79 offen offset:3072 sc1
    v_mfma_f32_16x16x32_bf16 v[60:63], v[124:127], v[244:247], v[60:63]
    s_waitcnt vmcnt(13)
    v_mfma_f32_16x16x32_bf16 v[64:67], v[112:115], v[248:251], v[64:67]
    v_mfma_f32_16x16x32_bf16 v[68:71], v[116:119], v[248:251], v[68:71]
    v_mfma_f32_16x16x32_bf16 v[72:75], v[120:123], v[248:251], v[72:75]
    s_add_u32 s79, s74, 3682304
    buffer_load_dwordx4 v[240:243], v21, s[44:47], s79 offen offset:0 sc1
    v_mfma_f32_16x16x32_bf16 v[76:79], v[124:127], v[248:251], v[76:79]
    s_waitcnt vmcnt(13)
    v_mfma_f32_16x16x32_bf16 v[80:83], v[112:115], v[252:255], v[80:83]
    v_mfma_f32_16x16x32_bf16 v[84:87], v[116:119], v[252:255], v[84:87]
    v_mfma_f32_16x16x32_bf16 v[88:91], v[120:123], v[252:255], v[88:91]
    buffer_load_dwordx4 v[244:247], v21, s[44:47], s79 offen offset:1024 sc1
    v_mfma_f32_16x16x32_bf16 v[92:95], v[124:127], v[252:255], v[92:95]
    s_waitcnt vmcnt(13)
    v_mfma_f32_16x16x32_bf16 v[32:35], v[128:131], v[192:195], v[32:35]
    v_mfma_f32_16x16x32_bf16 v[36:39], v[132:135], v[192:195], v[36:39]
    v_add_u32 v15, 65536, v15
    v_add_u32 v16, 65536, v16
    v_add_u32 v17, 65536, v17
    v_add_u32 v18, 65536, v18
    ds_read_b64_tr_b16 v[144:145], v15 offset:0
    v_mfma_f32_16x16x32_bf16 v[40:43], v[136:139], v[192:195], v[40:43]
    buffer_load_dwordx4 v[248:251], v21, s[44:47], s79 offen offset:2048 sc1
    v_mfma_f32_16x16x32_bf16 v[44:47], v[140:143], v[192:195], v[44:47]
    ds_read_b64_tr_b16 v[148:149], v16 offset:0
    s_waitcnt vmcnt(13)
    v_mfma_f32_16x16x32_bf16 v[48:51], v[128:131], v[196:199], v[48:51]
    v_mfma_f32_16x16x32_bf16 v[52:55], v[132:135], v[196:199], v[52:55]
    ds_read_b64_tr_b16 v[152:153], v17 offset:0
    v_mfma_f32_16x16x32_bf16 v[56:59], v[136:139], v[196:199], v[56:59]
    buffer_load_dwordx4 v[252:255], v21, s[44:47], s79 offen offset:3072 sc1
    v_mfma_f32_16x16x32_bf16 v[60:63], v[140:143], v[196:199], v[60:63]
    ds_read_b64_tr_b16 v[156:157], v18 offset:0
    s_waitcnt vmcnt(13)
    v_mfma_f32_16x16x32_bf16 v[64:67], v[128:131], v[200:203], v[64:67]
    v_mfma_f32_16x16x32_bf16 v[68:71], v[132:135], v[200:203], v[68:71]
    ds_read_b64_tr_b16 v[146:147], v15 offset:2048
    v_mfma_f32_16x16x32_bf16 v[72:75], v[136:139], v[200:203], v[72:75]
    s_add_u32 s79, s74, 16384
    buffer_load_dwordx4 v[192:195], v21, s[44:47], s79 offen offset:0 sc1
    v_mfma_f32_16x16x32_bf16 v[76:79], v[140:143], v[200:203], v[76:79]
    ds_read_b64_tr_b16 v[150:151], v16 offset:2048
    s_waitcnt vmcnt(13)
    v_mfma_f32_16x16x32_bf16 v[80:83], v[128:131], v[204:207], v[80:83]
    v_mfma_f32_16x16x32_bf16 v[84:87], v[132:135], v[204:207], v[84:87]
    ds_read_b64_tr_b16 v[154:155], v17 offset:2048
    v_mfma_f32_16x16x32_bf16 v[88:91], v[136:139], v[204:207], v[88:91]
    buffer_load_dwordx4 v[196:199], v21, s[44:47], s79 offen offset:1024 sc1
    v_mfma_f32_16x16x32_bf16 v[92:95], v[140:143], v[204:207], v[92:95]
    ds_read_b64_tr_b16 v[158:159], v18 offset:2048
    s_waitcnt vmcnt(13)
    v_mfma_f32_16x16x32_bf16 v[32:35], v[96:99], v[208:211], v[32:35]
    v_mfma_f32_16x16x32_bf16 v[36:39], v[100:103], v[208:211], v[36:39]
    ds_read_b64_tr_b16 v[160:161], v15 offset:4096
    v_mfma_f32_16x16x32_bf16 v[40:43], v[104:107], v[208:211], v[40:43]
    buffer_load_dwordx4 v[200:203], v21, s[44:47], s79 offen offset:2048 sc1
    v_mfma_f32_16x16x32_bf16 v[44:47], v[108:111], v[208:211], v[44:47]
    ds_read_b64_tr_b16 v[164:165], v16 offset:4096
    s_waitcnt vmcnt(13)
    v_mfma_f32_16x16x32_bf16 v[48:51], v[96:99], v[212:215], v[48:51]
    v_mfma_f32_16x16x32_bf16 v[52:55], v[100:103], v[212:215], v[52:55]
    ds_read_b64_tr_b16 v[168:169], v17 offset:4096
    v_mfma_f32_16x16x32_bf16 v[56:59], v[104:107], v[212:215], v[56:59]
    buffer_load_dwordx4 v[204:207], v21, s[44:47], s79 offen offset:3072 sc1
    v_mfma_f32_16x16x32_bf16 v[60:63], v[108:111], v[212:215], v[60:63]
    ds_read_b64_tr_b16 v[172:173], v18 offset:4096
    s_waitcnt vmcnt(13)
    v_mfma_f32_16x16x32_bf16 v[64:67], v[96:99], v[216:219], v[64:67]
    v_mfma_f32_16x16x32_bf16 v[68:71], v[100:103], v[216:219], v[68:71]
    ds_read_b64_tr_b16 v[162:163], v15 offset:6144
    v_mfma_f32_16x16x32_bf16 v[72:75], v[104:107], v[216:219], v[72:75]
    s_add_u32 s79, s74, 3686400
    buffer_load_dwordx4 v[208:211], v21, s[44:47], s79 offen offset:0 sc1
    v_mfma_f32_16x16x32_bf16 v[76:79], v[108:111], v[216:219], v[76:79]
    ds_read_b64_tr_b16 v[166:167], v16 offset:6144
    s_waitcnt vmcnt(13)
    v_mfma_f32_16x16x32_bf16 v[80:83], v[96:99], v[220:223], v[80:83]
    v_mfma_f32_16x16x32_bf16 v[84:87], v[100:103], v[220:223], v[84:87]
    ds_read_b64_tr_b16 v[170:171], v17 offset:6144
    v_mfma_f32_16x16x32_bf16 v[88:91], v[104:107], v[220:223], v[88:91]
    buffer_load_dwordx4 v[212:215], v21, s[44:47], s79 offen offset:1024 sc1
    v_mfma_f32_16x16x32_bf16 v[92:95], v[108:111], v[220:223], v[92:95]
    ds_read_b64_tr_b16 v[174:175], v18 offset:6144
    s_waitcnt vmcnt(13) lgkmcnt(11)
    v_mfma_f32_16x16x32_bf16 v[32:35], v[144:147], v[224:227], v[32:35]
    s_waitcnt lgkmcnt(10)
    v_mfma_f32_16x16x32_bf16 v[36:39], v[148:151], v[224:227], v[36:39]
    v_add_u32 v15, -65536, v15
    v_add_u32 v16, -65536, v16
    v_add_u32 v17, -65536, v17
    v_add_u32 v18, -65536, v18
    ds_read_b64_tr_b16 v[176:177], v15 offset:0
    s_waitcnt lgkmcnt(10)
    v_mfma_f32_16x16x32_bf16 v[40:43], v[152:155], v[224:227], v[40:43]
    buffer_load_dwordx4 v[216:219], v21, s[44:47], s79 offen offset:2048 sc1
    s_waitcnt lgkmcnt(9)
    v_mfma_f32_16x16x32_bf16 v[44:47], v[156:159], v[224:227], v[44:47]
    ds_read_b64_tr_b16 v[180:181], v16 offset:0
    s_waitcnt vmcnt(13)
    v_mfma_f32_16x16x32_bf16 v[48:51], v[144:147], v[228:231], v[48:51]
    v_mfma_f32_16x16x32_bf16 v[52:55], v[148:151], v[228:231], v[52:55]
    ds_read_b64_tr_b16 v[184:185], v17 offset:0
    v_mfma_f32_16x16x32_bf16 v[56:59], v[152:155], v[228:231], v[56:59]
    buffer_load_dwordx4 v[220:223], v21, s[44:47], s79 offen offset:3072 sc1
    v_mfma_f32_16x16x32_bf16 v[60:63], v[156:159], v[228:231], v[60:63]
    ds_read_b64_tr_b16 v[188:189], v18 offset:0
    s_waitcnt vmcnt(13)
    v_mfma_f32_16x16x32_bf16 v[64:67], v[144:147], v[232:235], v[64:67]
    v_mfma_f32_16x16x32_bf16 v[68:71], v[148:151], v[232:235], v[68:71]
    ds_read_b64_tr_b16 v[178:179], v15 offset:2048
    v_mfma_f32_16x16x32_bf16 v[72:75], v[152:155], v[232:235], v[72:75]
    s_add_u32 s79, s74, 20480
    buffer_load_dwordx4 v[224:227], v21, s[44:47], s79 offen offset:0 sc1
    v_mfma_f32_16x16x32_bf16 v[76:79], v[156:159], v[232:235], v[76:79]
    ds_read_b64_tr_b16 v[182:183], v16 offset:2048
    s_waitcnt vmcnt(13)
    v_mfma_f32_16x16x32_bf16 v[80:83], v[144:147], v[236:239], v[80:83]
    v_mfma_f32_16x16x32_bf16 v[84:87], v[148:151], v[236:239], v[84:87]
    ds_read_b64_tr_b16 v[186:187], v17 offset:2048
    v_mfma_f32_16x16x32_bf16 v[88:91], v[152:155], v[236:239], v[88:91]
    buffer_load_dwordx4 v[228:231], v21, s[44:47], s79 offen offset:1024 sc1
    v_mfma_f32_16x16x32_bf16 v[92:95], v[156:159], v[236:239], v[92:95]
    ds_read_b64_tr_b16 v[190:191], v18 offset:2048
    s_waitcnt vmcnt(13) lgkmcnt(11)
    v_mfma_f32_16x16x32_bf16 v[32:35], v[160:163], v[240:243], v[32:35]
    s_waitcnt lgkmcnt(10)
    v_mfma_f32_16x16x32_bf16 v[36:39], v[164:167], v[240:243], v[36:39]
    ds_read_b64_tr_b16 v[144:145], v15 offset:4096
    s_waitcnt lgkmcnt(10)
    v_mfma_f32_16x16x32_bf16 v[40:43], v[168:171], v[240:243], v[40:43]
    buffer_load_dwordx4 v[232:235], v21, s[44:47], s79 offen offset:2048 sc1
    s_waitcnt lgkmcnt(9)
    v_mfma_f32_16x16x32_bf16 v[44:47], v[172:175], v[240:243], v[44:47]
    ds_read_b64_tr_b16 v[148:149], v16 offset:4096
    s_waitcnt vmcnt(13)
    v_mfma_f32_16x16x32_bf16 v[48:51], v[160:163], v[244:247], v[48:51]
    v_mfma_f32_16x16x32_bf16 v[52:55], v[164:167], v[244:247], v[52:55]
    ds_read_b64_tr_b16 v[152:153], v17 offset:4096
    v_mfma_f32_16x16x32_bf16 v[56:59], v[168:171], v[244:247], v[56:59]
    buffer_load_dwordx4 v[236:239], v21, s[44:47], s79 offen offset:3072 sc1
    v_mfma_f32_16x16x32_bf16 v[60:63], v[172:175], v[244:247], v[60:63]
    ds_read_b64_tr_b16 v[156:157], v18 offset:4096
    s_waitcnt vmcnt(13)
    v_mfma_f32_16x16x32_bf16 v[64:67], v[160:163], v[248:251], v[64:67]
    s_add_u32 s79, s74, 3690496
    buffer_load_dwordx4 v[96:99], v21, s[44:47], s79 offen offset:0 sc1
    v_mfma_f32_16x16x32_bf16 v[68:71], v[164:167], v[248:251], v[68:71]
    ds_read_b64_tr_b16 v[146:147], v15 offset:6144
    v_mfma_f32_16x16x32_bf16 v[72:75], v[168:171], v[248:251], v[72:75]
    buffer_load_dwordx4 v[100:103], v21, s[44:47], s79 offen offset:1024 sc1
    v_mfma_f32_16x16x32_bf16 v[76:79], v[172:175], v[248:251], v[76:79]
    ds_read_b64_tr_b16 v[150:151], v16 offset:6144
    s_waitcnt vmcnt(14)
    v_mfma_f32_16x16x32_bf16 v[80:83], v[160:163], v[252:255], v[80:83]
    s_add_u32 m0, s73, 69632
    s_add_u32 s76, s75, 372736
    buffer_load_dwordx4 v19, s[40:43], s76 offen lds
    v_mfma_f32_16x16x32_bf16 v[84:87], v[164:167], v[252:255], v[84:87]
    ds_read_b64_tr_b16 v[154:155], v17 offset:6144
    v_mfma_f32_16x16x32_bf16 v[88:91], v[168:171], v[252:255], v[88:91]
    buffer_load_dwordx4 v20, s[40:43], s76 offen offset:1024 lds
    v_mfma_f32_16x16x32_bf16 v[92:95], v[172:175], v[252:255], v[92:95]
    ds_read_b64_tr_b16 v[158:159], v18 offset:6144
    s_waitcnt vmcnt(15) lgkmcnt(11)
    v_mfma_f32_16x16x32_bf16 v[32:35], v[176:179], v[192:195], v[32:35]
    s_add_u32 s79, s74, 24576
    buffer_load_dwordx4 v[112:115], v21, s[44:47], s79 offen offset:0 sc1
    s_waitcnt lgkmcnt(10)
    v_mfma_f32_16x16x32_bf16 v[36:39], v[180:183], v[192:195], v[36:39]
    ds_read_b64_tr_b16 v[160:161], v15 offset:32768
    s_waitcnt lgkmcnt(10)
    v_mfma_f32_16x16x32_bf16 v[40:43], v[184:187], v[192:195], v[40:43]
    buffer_load_dwordx4 v[116:119], v21, s[44:47], s79 offen offset:1024 sc1
    s_waitcnt lgkmcnt(9)
    v_mfma_f32_16x16x32_bf16 v[44:47], v[188:191], v[192:195], v[44:47]
    ds_read_b64_tr_b16 v[164:165], v16 offset:32768
    s_waitcnt vmcnt(16)
    v_mfma_f32_16x16x32_bf16 v[48:51], v[176:179], v[196:199], v[48:51]
    s_add_u32 m0, s73, 71680
    s_add_u32 s76, s75, 387072
    buffer_load_dwordx4 v19, s[40:43], s76 offen lds
    v_mfma_f32_16x16x32_bf16 v[52:55], v[180:183], v[196:199], v[52:55]
    ds_read_b64_tr_b16 v[168:169], v17 offset:32768
    v_mfma_f32_16x16x32_bf16 v[56:59], v[184:187], v[196:199], v[56:59]
    buffer_load_dwordx4 v20, s[40:43], s76 offen offset:1024 lds
    v_mfma_f32_16x16x32_bf16 v[60:63], v[188:191], v[196:199], v[60:63]
    ds_read_b64_tr_b16 v[172:173], v18 offset:32768
    s_waitcnt vmcnt(17)
    v_mfma_f32_16x16x32_bf16 v[64:67], v[176:179], v[200:203], v[64:67]
    v_mfma_f32_16x16x32_bf16 v[68:71], v[180:183], v[200:203], v[68:71]
    ds_read_b64_tr_b16 v[162:163], v15 offset:34816
    v_mfma_f32_16x16x32_bf16 v[72:75], v[184:187], v[200:203], v[72:75]
    s_add_u32 s79, s74, 3694592
    buffer_load_dwordx4 v[128:131], v21, s[44:47], s79 offen offset:0 sc1
    v_mfma_f32_16x16x32_bf16 v[76:79], v[188:191], v[200:203], v[76:79]
    ds_read_b64_tr_b16 v[166:167], v16 offset:34816
    s_waitcnt vmcnt(17)
    v_mfma_f32_16x16x32_bf16 v[80:83], v[176:179], v[204:207], v[80:83]
    v_mfma_f32_16x16x32_bf16 v[84:87], v[180:183], v[204:207], v[84:87]
    ds_read_b64_tr_b16 v[170:171], v17 offset:34816
    v_mfma_f32_16x16x32_bf16 v[88:91], v[184:187], v[204:207], v[88:91]
    buffer_load_dwordx4 v[132:135], v21, s[44:47], s79 offen offset:1024 sc1
    v_mfma_f32_16x16x32_bf16 v[92:95], v[188:191], v[204:207], v[92:95]
    ds_read_b64_tr_b16 v[174:175], v18 offset:34816
    s_waitcnt vmcnt(17) lgkmcnt(11)
    v_mfma_f32_16x16x32_bf16 v[32:35], v[144:147], v[208:211], v[32:35]
    s_waitcnt lgkmcnt(10)
    v_mfma_f32_16x16x32_bf16 v[36:39], v[148:151], v[208:211], v[36:39]
    ds_read_b64_tr_b16 v[176:177], v15 offset:36864
    s_waitcnt lgkmcnt(10)
    v_mfma_f32_16x16x32_bf16 v[40:43], v[152:155], v[208:211], v[40:43]
    s_add_u32 s79, s74, 3690496
    buffer_load_dwordx4 v[104:107], v21, s[44:47], s79 offen offset:2048 sc1
    s_waitcnt lgkmcnt(9)
    v_mfma_f32_16x16x32_bf16 v[44:47], v[156:159], v[208:211], v[44:47]
    ds_read_b64_tr_b16 v[180:181], v16 offset:36864
    s_waitcnt vmcnt(17)
    v_mfma_f32_16x16x32_bf16 v[48:51], v[144:147], v[212:215], v[48:51]
    v_mfma_f32_16x16x32_bf16 v[52:55], v[148:151], v[212:215], v[52:55]
    ds_read_b64_tr_b16 v[184:185], v17 offset:36864
    v_mfma_f32_16x16x32_bf16 v[56:59], v[152:155], v[212:215], v[56:59]
    buffer_load_dwordx4 v[108:111], v21, s[44:47], s79 offen offset:3072 sc1
    v_mfma_f32_16x16x32_bf16 v[60:63], v[156:159], v[212:215], v[60:63]
    ds_read_b64_tr_b16 v[188:189], v18 offset:36864
    s_waitcnt vmcnt(17)
    v_mfma_f32_16x16x32_bf16 v[64:67], v[144:147], v[216:219], v[64:67]
    v_mfma_f32_16x16x32_bf16 v[68:71], v[148:151], v[216:219], v[68:71]
    ds_read_b64_tr_b16 v[178:179], v15 offset:38912
    v_mfma_f32_16x16x32_bf16 v[72:75], v[152:155], v[216:219], v[72:75]
    s_add_u32 s79, s74, 24576
    buffer_load_dwordx4 v[120:123], v21, s[44:47], s79 offen offset:2048 sc1
    v_mfma_f32_16x16x32_bf16 v[76:79], v[156:159], v[216:219], v[76:79]
    ds_read_b64_tr_b16 v[182:183], v16 offset:38912
    s_waitcnt vmcnt(17)
    v_mfma_f32_16x16x32_bf16 v[80:83], v[144:147], v[220:223], v[80:83]
    v_mfma_f32_16x16x32_bf16 v[84:87], v[148:151], v[220:223], v[84:87]
    ds_read_b64_tr_b16 v[186:187], v17 offset:38912
    v_mfma_f32_16x16x32_bf16 v[88:91], v[152:155], v[220:223], v[88:91]
    buffer_load_dwordx4 v[124:127], v21, s[44:47], s79 offen offset:3072 sc1
    v_mfma_f32_16x16x32_bf16 v[92:95], v[156:159], v[220:223], v[92:95]
    ds_read_b64_tr_b16 v[190:191], v18 offset:38912
    s_waitcnt vmcnt(17) lgkmcnt(11)
    v_mfma_f32_16x16x32_bf16 v[32:35], v[160:163], v[224:227], v[32:35]
    s_waitcnt lgkmcnt(10)
    v_mfma_f32_16x16x32_bf16 v[36:39], v[164:167], v[224:227], v[36:39]
    v_add_u32 v15, s88, v15
    v_add_u32 v16, s88, v16
    v_add_u32 v17, s88, v17
    v_add_u32 v18, s88, v18
    ds_read_b64_tr_b16 v[144:145], v15 offset:0
    s_waitcnt lgkmcnt(10)
    v_mfma_f32_16x16x32_bf16 v[40:43], v[168:171], v[224:227], v[40:43]
    s_add_u32 s79, s74, 3694592
    buffer_load_dwordx4 v[136:139], v21, s[44:47], s79 offen offset:2048 sc1
    s_waitcnt lgkmcnt(9)
    v_mfma_f32_16x16x32_bf16 v[44:47], v[172:175], v[224:227], v[44:47]
    ds_read_b64_tr_b16 v[148:149], v16 offset:0
    s_waitcnt vmcnt(17)
    v_mfma_f32_16x16x32_bf16 v[48:51], v[160:163], v[228:231], v[48:51]
    v_mfma_f32_16x16x32_bf16 v[52:55], v[164:167], v[228:231], v[52:55]
    ds_read_b64_tr_b16 v[152:153], v17 offset:0
    v_mfma_f32_16x16x32_bf16 v[56:59], v[168:171], v[228:231], v[56:59]
    buffer_load_dwordx4 v[140:143], v21, s[44:47], s79 offen offset:3072 sc1
    v_mfma_f32_16x16x32_bf16 v[60:63], v[172:175], v[228:231], v[60:63]
    ds_read_b64_tr_b16 v[156:157], v18 offset:0
    s_waitcnt vmcnt(17)
    v_mfma_f32_16x16x32_bf16 v[64:67], v[160:163], v[232:235], v[64:67]
    v_mfma_f32_16x16x32_bf16 v[68:71], v[164:167], v[232:235], v[68:71]
    ds_read_b64_tr_b16 v[146:147], v15 offset:2048
    v_mfma_f32_16x16x32_bf16 v[72:75], v[168:171], v[232:235], v[72:75]
    buffer_load_dword v30, v13, s[44:47], s78 offen sc1
    v_mfma_f32_16x16x32_bf16 v[76:79], v[172:175], v[232:235], v[76:79]
    ds_read_b64_tr_b16 v[150:151], v16 offset:2048
    s_waitcnt vmcnt(17)
    v_mfma_f32_16x16x32_bf16 v[80:83], v[160:163], v[236:239], v[80:83]
    v_mfma_f32_16x16x32_bf16 v[84:87], v[164:167], v[236:239], v[84:87]
    ds_read_b64_tr_b16 v[154:155], v17 offset:2048
    v_mfma_f32_16x16x32_bf16 v[88:91], v[168:171], v[236:239], v[88:91]
    buffer_load_dwordx4 v[6:9], v5, s[36:39], s70 offen
    v_mfma_f32_16x16x32_bf16 v[92:95], v[172:175], v[236:239], v[92:95]
    ds_read_b64_tr_b16 v[158:159], v18 offset:2048
    s_waitcnt vmcnt(17) lgkmcnt(11)
    v_mfma_f32_16x16x32_bf16 v[32:35], v[176:179], v[96:99], v[32:35]
    v_add_u32 v15, s89, v15
    v_add_u32 v16, s89, v16
    v_add_u32 v17, s89, v17
    v_add_u32 v18, s89, v18
    s_waitcnt vmcnt(14)
    ds_read_b64_tr_b16 v[160:161], v15 offset:4096
    s_waitcnt lgkmcnt(11)
    v_mfma_f32_16x16x32_bf16 v[36:39], v[180:183], v[96:99], v[36:39]
    ds_read_b64_tr_b16 v[164:165], v16 offset:4096
    s_waitcnt lgkmcnt(11)
    v_mfma_f32_16x16x32_bf16 v[40:43], v[184:187], v[96:99], v[40:43]
    ds_read_b64_tr_b16 v[168:169], v17 offset:4096
    s_waitcnt lgkmcnt(11)
    v_mfma_f32_16x16x32_bf16 v[44:47], v[188:191], v[96:99], v[44:47]
    ds_read_b64_tr_b16 v[172:173], v18 offset:4096
    v_mfma_f32_16x16x32_bf16 v[48:51], v[176:179], v[100:103], v[48:51]
    s_waitcnt vmcnt(10)
    ds_read_b64_tr_b16 v[162:163], v15 offset:6144
    v_mfma_f32_16x16x32_bf16 v[52:55], v[180:183], v[100:103], v[52:55]
    ds_read_b64_tr_b16 v[166:167], v16 offset:6144
    v_mfma_f32_16x16x32_bf16 v[56:59], v[184:187], v[100:103], v[56:59]
    ds_read_b64_tr_b16 v[170:171], v17 offset:6144
    v_mfma_f32_16x16x32_bf16 v[60:63], v[188:191], v[100:103], v[60:63]
    ds_read_b64_tr_b16 v[174:175], v18 offset:6144
    s_waitcnt lgkmcnt(11)
    v_mfma_f32_16x16x32_bf16 v[32:35], v[144:147], v[112:115], v[32:35]
    s_waitcnt lgkmcnt(10)
    v_mfma_f32_16x16x32_bf16 v[36:39], v[148:151], v[112:115], v[36:39]
    s_waitcnt lgkmcnt(9)
    v_mfma_f32_16x16x32_bf16 v[40:43], v[152:155], v[112:115], v[40:43]
    s_waitcnt lgkmcnt(8)
    v_mfma_f32_16x16x32_bf16 v[44:47], v[156:159], v[112:115], v[44:47]
    v_mfma_f32_16x16x32_bf16 v[48:51], v[144:147], v[116:119], v[48:51]
    v_mfma_f32_16x16x32_bf16 v[52:55], v[148:151], v[116:119], v[52:55]
    v_mfma_f32_16x16x32_bf16 v[56:59], v[152:155], v[116:119], v[56:59]
    v_mfma_f32_16x16x32_bf16 v[60:63], v[156:159], v[116:119], v[60:63]
    s_waitcnt vmcnt(9) lgkmcnt(3)
    v_mfma_f32_16x16x32_bf16 v[32:35], v[160:163], v[128:131], v[32:35]
    s_waitcnt lgkmcnt(2)
    v_mfma_f32_16x16x32_bf16 v[36:39], v[164:167], v[128:131], v[36:39]
    s_waitcnt lgkmcnt(1)
    v_mfma_f32_16x16x32_bf16 v[40:43], v[168:171], v[128:131], v[40:43]
    s_waitcnt lgkmcnt(0)
    v_mfma_f32_16x16x32_bf16 v[44:47], v[172:175], v[128:131], v[44:47]
    s_waitcnt vmcnt(8)
    v_mfma_f32_16x16x32_bf16 v[48:51], v[160:163], v[132:135], v[48:51]
    v_mfma_f32_16x16x32_bf16 v[52:55], v[164:167], v[132:135], v[52:55]
    v_mfma_f32_16x16x32_bf16 v[56:59], v[168:171], v[132:135], v[56:59]
    v_mfma_f32_16x16x32_bf16 v[60:63], v[172:175], v[132:135], v[60:63]
    s_waitcnt vmcnt(7)
    v_mfma_f32_16x16x32_bf16 v[64:67], v[176:179], v[104:107], v[64:67]
    v_mfma_f32_16x16x32_bf16 v[68:71], v[180:183], v[104:107], v[68:71]
    v_mfma_f32_16x16x32_bf16 v[72:75], v[184:187], v[104:107], v[72:75]
    v_mfma_f32_16x16x32_bf16 v[76:79], v[188:191], v[104:107], v[76:79]
    s_waitcnt vmcnt(6)
    v_mfma_f32_16x16x32_bf16 v[80:83], v[176:179], v[108:111], v[80:83]
    v_mfma_f32_16x16x32_bf16 v[84:87], v[180:183], v[108:111], v[84:87]
    ds_write_b128 v1, v[32:35] offset:0
    v_mfma_f32_16x16x32_bf16 v[88:91], v[184:187], v[108:111], v[88:91]
    v_mfma_f32_16x16x32_bf16 v[92:95], v[188:191], v[108:111], v[92:95]
    s_waitcnt vmcnt(5)
    v_mfma_f32_16x16x32_bf16 v[64:67], v[144:147], v[120:123], v[64:67]
    ds_write_b128 v2, v[36:39] offset:0
    v_mfma_f32_16x16x32_bf16 v[68:71], v[148:151], v[120:123], v[68:71]
    v_mfma_f32_16x16x32_bf16 v[72:75], v[152:155], v[120:123], v[72:75]
    ds_write_b128 v3, v[40:43] offset:0
    v_mfma_f32_16x16x32_bf16 v[76:79], v[156:159], v[120:123], v[76:79]
    s_waitcnt vmcnt(4)
    v_mfma_f32_16x16x32_bf16 v[80:83], v[144:147], v[124:127], v[80:83]
    v_mfma_f32_16x16x32_bf16 v[84:87], v[148:151], v[124:127], v[84:87]
    ds_write_b128 v4, v[44:47] offset:0
    v_mfma_f32_16x16x32_bf16 v[88:91], v[152:155], v[124:127], v[88:91]
    v_mfma_f32_16x16x32_bf16 v[92:95], v[156:159], v[124:127], v[92:95]
    s_waitcnt vmcnt(3)
    v_mfma_f32_16x16x32_bf16 v[64:67], v[160:163], v[136:139], v[64:67]
    ds_write_b128 v3, v[48:51] offset:4096
    v_mfma_f32_16x16x32_bf16 v[68:71], v[164:167], v[136:139], v[68:71]
    v_mfma_f32_16x16x32_bf16 v[72:75], v[168:171], v[136:139], v[72:75]
    ds_write_b128 v4, v[52:55] offset:4096
    v_mfma_f32_16x16x32_bf16 v[76:79], v[172:175], v[136:139], v[76:79]
    s_waitcnt vmcnt(2)
    v_mfma_f32_16x16x32_bf16 v[80:83], v[160:163], v[140:143], v[80:83]
    v_mfma_f32_16x16x32_bf16 v[84:87], v[164:167], v[140:143], v[84:87]
    ds_write_b128 v1, v[56:59] offset:4096
    v_mfma_f32_16x16x32_bf16 v[88:91], v[168:171], v[140:143], v[88:91]
    v_mfma_f32_16x16x32_bf16 v[92:95], v[172:175], v[140:143], v[92:95]
    ds_write_b128 v2, v[60:63] offset:4096
    s_mov_b64 exec, 1
    ds_write_b32 v29, v24 offset:80
    s_mov_b64 exec, -1
L_hop4:
    s_cbranch_execz L_hopped
    ds_write_b128 v1, v[64:67] offset:32768
    ds_write_b128 v2, v[68:71] offset:32768
    ds_write_b128 v3, v[72:75] offset:32768
    ds_write_b128 v4, v[76:79] offset:32768
    ds_read_b32 v26, v29 offset:112
    ds_write_b128 v3, v[80:83] offset:36864
    ds_write_b128 v4, v[84:87] offset:36864
    ds_write_b128 v1, v[88:91] offset:36864
    ds_write_b128 v2, v[92:95] offset:36864
    s_mov_b64 exec, 1
    ds_write_b32 v29, v24 offset:96
    s_mov_b64 exec, -1
    s_waitcnt lgkmcnt(5)
    v_cmp_ne_u32 vcc, s52, v26
    s_waitcnt vmcnt(1)
    v_and_b32 v30, 0xffff0000, v30
    v_rcp_f32 v30, v30
    s_waitcnt vmcnt(0)
    v_lshlrev_b32 v100, 16, v6
    v_and_b32 v101, 0xffff0000, v6
    v_lshlrev_b32 v102, 16, v7
    v_and_b32 v103, 0xffff0000, v7
    s_cbranch_vccz L_pass_31
    s_mov_b32 s96, 0
L_spin_32:
    ds_read_b32 v26, v29 offset:112
    s_add_u32 s96, s96, 1
    s_cmp_gt_u32 s96, 1048576
    s_waitcnt lgkmcnt(0)
    v_cmp_ne_u32 vcc, s52, v26
    s_cbranch_scc1 L_spun_33
    s_nop 3
    s_cbranch_vccnz L_spin_32
L_spun_33:
L_pass_31:
    ds_read_b32 v176, v12 offset:0
    ds_read_b32 v177, v12 offset:64
    ds_read_b32 v178, v12 offset:128
    ds_read_b32 v179, v12 offset:192
    ds_read_b32 v25, v14 offset:96
    v_lshlrev_b32 v104, 16, v8
    v_and_b32 v105, 0xffff0000, v8
    v_lshlrev_b32 v106, 16, v9
    v_and_b32 v107, 0xffff0000, v9
    v_mul_f32 v116, 3216550459, v30
    v_mul_f32 v117, 3216550459, v30
    s_waitcnt lgkmcnt(0)
    v_cmp_ne_u32 vcc, s52, v25
    v_lshlrev_b32 v108, 16, v176
    v_and_b32 v109, 0xffff0000, v176
    v_lshlrev_b32 v110, 16, v177
    v_and_b32 v111, 0xffff0000, v177
    v_lshlrev_b32 v112, 16, v178
    s_cbranch_vccz L_pass_34
    s_mov_b32 s96, 0
L_spin_35:
    ds_read_b32 v25, v14 offset:96
    s_add_u32 s96, s96, 1
    s_cmp_gt_u32 s96, 1048576
    s_waitcnt lgkmcnt(0)
    v_cmp_ne_u32 vcc, s52, v25
    s_cbranch_scc1 L_spun_36
    s_nop 3
    s_cbranch_vccnz L_spin_35
L_spun_36:
L_pass_34:
    ds_read_b128 v[192:195], v10 offset:0
    ds_read_b128 v[196:199], v11 offset:0
    ds_read_b128 v[200:203], v10 offset:8192
    ds_read_b128 v[204:207], v11 offset:8192
    ds_read_b128 v[208:211], v10 offset:16384
    ds_read_b128 v[212:215], v11 offset:16384
    ds_read_b128 v[216:219], v10 offset:24576
    ds_read_b128 v[220:223], v11 offset:24576
    v_and_b32 v113, 0xffff0000, v178
    v_lshlrev_b32 v114, 16, v179
    v_and_b32 v115, 0xffff0000, v179
    v_mul_f32 v108, v108, v30
    v_mul_f32 v109, v109, v30
    v_mul_f32 v110, v110, v30
    v_mul_f32 v111, v111, v30
    v_mul_f32 v112, v112, v30
    v_mul_f32 v113, v113, v30
    v_mul_f32 v114, v114, v30
    v_mul_f32_e64 v115, v115, v30
    s_waitcnt lgkmcnt(5)
    v_pk_add_f32 v[192:193], v[192:193], v[200:201]
    v_pk_add_f32 v[194:195], v[194:195], v[202:203]
    s_waitcnt lgkmcnt(4)
    v_pk_add_f32 v[196:197], v[196:197], v[204:205]
    v_pk_add_f32 v[198:199], v[198:199], v[206:207]
    s_waitcnt lgkmcnt(1)
    v_pk_add_f32 v[208:209], v[208:209], v[216:217]
    v_pk_add_f32 v[210:211], v[210:211], v[218:219]
    s_waitcnt lgkmcnt(0)
    s_nop 0
    v_pk_add_f32 v[212:213], v[212:213], v[220:221]
    v_pk_add_f32 v[214:215], v[214:215], v[222:223]
    v_pk_add_f32 v[192:193], v[192:193], v[208:209]
    v_pk_add_f32 v[194:195], v[194:195], v[210:211]
    v_pk_add_f32 v[196:197], v[196:197], v[212:213]
    v_pk_add_f32 v[198:199], v[198:199], v[214:215]
    v_pk_mul_f32 v[200:201], v[192:193], v[116:117]
    v_pk_mul_f32 v[202:203], v[194:195], v[116:117]
    v_pk_mul_f32 v[204:205], v[196:197], v[116:117]
    v_pk_mul_f32 v[206:207], v[198:199], v[116:117]
    v_exp_f32 v200, v200
    v_exp_f32 v201, v201
    v_exp_f32 v202, v202
    v_exp_f32 v203, v203
    v_exp_f32 v204, v204
    v_exp_f32 v205, v205
    v_exp_f32 v206, v206
    v_exp_f32 v207, v207
    v_pk_mul_f32 v[192:193], v[192:193], v[108:109]
    v_pk_mul_f32 v[194:195], v[194:195], v[110:111]
    v_pk_mul_f32 v[196:197], v[196:197], v[112:113]
    v_pk_mul_f32 v[198:199], v[198:199], v[114:115]
    v_pk_add_f32 v[200:201], v[200:201], 1.0 op_sel_hi:[1,0]
    v_pk_add_f32 v[202:203], v[202:203], 1.0 op_sel_hi:[1,0]
    v_pk_add_f32 v[204:205], v[204:205], 1.0 op_sel_hi:[1,0]
    v_pk_add_f32 v[206:207], v[206:207], 1.0 op_sel_hi:[1,0]
    v_rcp_f32 v200, v200
    v_rcp_f32 v201, v201
    v_rcp_f32 v202, v202
    v_rcp_f32 v203, v203
    v_rcp_f32 v204, v204
    v_rcp_f32 v205, v205
    v_rcp_f32 v206, v206
    v_rcp_f32 v207, v207
    v_pk_fma_f32 v[192:193], v[192:193], v[200:201], v[100:101]
    v_pk_fma_f32 v[194:195], v[194:195], v[202:203], v[102:103]
    v_pk_fma_f32 v[196:197], v[196:197], v[204:205], v[104:105]
    v_pk_fma_f32 v[198:199], v[198:199], v[206:207], v[106:107]
    v_cvt_pk_bf16_f32 v208, v192, v193
    v_cvt_pk_bf16_f32 v209, v194, v195
    v_cvt_pk_bf16_f32 v210, v196, v197
    v_cvt_pk_bf16_f32 v211, v198, v199
    buffer_store_dwordx4 v[208:211], v5, s[64:67], s70 offen nt
    s_endpgm
L_bodyH:
    s_load_dword s52, s[34:35], 0
    s_mov_b32 s44, s34
    s_mov_b32 s45, s35
    s_mov_b32 s40, s24
    s_mov_b32 s41, s25
    s_mov_b32 s42, 1605632
    s_mov_b32 s43, 0x20000
    s_mov_b32 s48, s28
    s_mov_b32 s49, s29
    s_mov_b32 s50, 1605632
    s_mov_b32 s51, 0x20000
    s_lshr_b32 s70, s55, 1
    s_lshl2_add_u32 s70, s70, s56
    s_sub_u32 s70, s70, 28
    s_and_b32 s71, s55, 1
    s_mul_i32 s71, s71, 14
    s_add_u32 s71, s71, s70
    s_lshl_b32 s62, s71, 7
    s_mul_i32 s66, s54, 200704
    s_add_u32 s66, s66, s62
    s_cmp_ge_u32 s70, 14
    s_cselect_b32 s66, 1605632, s66
    v_mul_u32_u24 v4, 3584, v3
    v_lshl_add_u32 v4, v2, 4, v4
    s_mov_b32 s67, 0x3f803f80
    s_mov_b32 s68, 0x00003f80
    s_mov_b32 s69, 0x3f800000
    s_lshl_b32 s65, s72, 6
    s_add_u32 s65, s65, 65536
    s_mul_i32 s62, s54, 7232
    s_add_u32 s62, s62, 8192
    v_add_u32 v1, s62, v1
    v_mov_b32 v80, 0
    v_mov_b32 v81, 0
    v_mov_b32 v82, 0
    v_mov_b32 v83, 0
    v_mov_b32 v88, 0
    v_mov_b32 v89, 0
    v_mov_b32 v90, 0
    v_mov_b32 v91, 0
    v_mov_b32 v92, 0
    v_mov_b32 v93, 0
    v_mov_b32 v94, 0
    v_mov_b32 v95, 0
    s_waitcnt lgkmcnt(0)
    s_add_u32 s52, s52, 2654435761
    s_mov_b32 s53, s52
    s_waitcnt vmcnt(6)
    v_dot2_f32_bf16 v80, v16, s67, v80
    v_dot2_f32_bf16 v82, v16, v16, v82
    v_dot2_f32_bf16 v81, v17, s67, v81
    v_dot2_f32_bf16 v83, v17, v17, v83
    v_dot2_f32_bf16 v80, v18, s67, v80
    v_dot2_f32_bf16 v82, v18, v18, v82
    v_dot2_f32_bf16 v81, v19, s67, v81
    v_dot2_f32_bf16 v83, v19, v19, v83
    s_waitcnt vmcnt(5)
    s_nop 0
    v_dot2_f32_bf16 v80, v20, s67, v80
    v_dot2_f32_bf16 v82, v20, v20, v82
    v_dot2_f32_bf16 v81, v21, s67, v81
    v_dot2_f32_bf16 v83, v21, v21, v83
    v_dot2_f32_bf16 v80, v22, s67, v80
    v_dot2_f32_bf16 v82, v22, v22, v82
    v_dot2_f32_bf16 v81, v23, s67, v81
    v_dot2_f32_bf16 v83, v23, v23, v83
    s_waitcnt vmcnt(4)
    s_nop 0
    v_dot2_f32_bf16 v80, v24, s67, v80
    v_dot2_f32_bf16 v82, v24, v24, v82
    v_dot2_f32_bf16 v81, v25, s67, v81
    v_dot2_f32_bf16 v83, v25, v25, v83
    v_dot2_f32_bf16 v80, v26, s67, v80
    v_dot2_f32_bf16 v82, v26, v26, v82
    v_dot2_f32_bf16 v81, v27, s67, v81
    v_dot2_f32_bf16 v83, v27, v27, v83
    s_waitcnt vmcnt(3)
    s_nop 0
    v_dot2_f32_bf16 v80, v28, s67, v80
    v_dot2_f32_bf16 v82, v28, v28, v82
    v_dot2_f32_bf16 v81, v29, s67, v81
    v_dot2_f32_bf16 v83, v29, v29, v83
    v_dot2_f32_bf16 v80, v30, s67, v80
    v_dot2_f32_bf16 v82, v30, v30, v82
    v_dot2_f32_bf16 v81, v31, s67, v81
    v_dot2_f32_bf16 v83, v31, v31, v83
    s_waitcnt vmcnt(2)
    s_nop 0
    v_dot2_f32_bf16 v80, v32, s67, v80
    v_dot2_f32_bf16 v82, v32, v32, v82
    v_dot2_f32_bf16 v81, v33, s67, v81
    v_dot2_f32_bf16 v83, v33, v33, v83
    v_dot2_f32_bf16 v80, v34, s67, v80
    v_dot2_f32_bf16 v82, v34, v34, v82
    v_dot2_f32_bf16 v81, v35, s67, v81
    v_dot2_f32_bf16 v83, v35, v35, v83
    s_waitcnt vmcnt(1)
    s_nop 0
    v_dot2_f32_bf16 v80, v36, s67, v80
    v_dot2_f32_bf16 v82, v36, v36, v82
    v_dot2_f32_bf16 v81, v37, s67, v81
    v_dot2_f32_bf16 v83, v37, v37, v83
    v_dot2_f32_bf16 v80, v38, s67, v80
    v_dot2_f32_bf16 v82, v38, v38, v82
    v_dot2_f32_bf16 v81, v39, s67, v81
    v_dot2_f32_bf16 v83, v39, v39, v83
    s_waitcnt vmcnt(0)
    s_nop 0
    v_dot2_f32_bf16 v80, v40, s67, v80
    v_dot2_f32_bf16 v82, v40, v40, v82
    v_dot2_f32_bf16 v81, v41, s67, v81
    v_dot2_f32_bf16 v83, v41, v41, v83
    v_dot2_f32_bf16 v80, v42, s67, v80
    v_dot2_f32_bf16 v82, v42, v42, v82
    v_dot2_f32_bf16 v81, v43, s67, v81
    v_dot2_f32_bf16 v83, v43, v43, v83
    s_nop 1
    v_add_f32 v80, v80, v81
    v_add_f32 v81, v82, v83
    s_nop 0
    v_add_f32_dpp v80, v80, v80 quad_perm:[1,0,3,2] row_mask:0xf bank_mask:0xf
    v_add_f32_dpp v81, v81, v81 quad_perm:[1,0,3,2] row_mask:0xf bank_mask:0xf
    s_nop 0
    v_add_f32_dpp v80, v80, v80 quad_perm:[2,3,0,1] row_mask:0xf bank_mask:0xf
    v_add_f32_dpp v81, v81, v81 quad_perm:[2,3,0,1] row_mask:0xf bank_mask:0xf
    s_nop 0
    v_add_f32_dpp v80, v80, v80 row_half_mirror row_mask:0xf bank_mask:0xf
    v_add_f32_dpp v81, v81, v81 row_half_mirror row_mask:0xf bank_mask:0xf
    v_mul_f32 v80, 991054117, v80
    v_mul_f32 v81, 991054117, v81
    v_fma_f32 v81, -v80, v80, v81
    v_max_f32_e64 v81, 0, v81
    v_cvt_pk_bf16_f32 v81, v81, v81
    v_and_b32 v81, 0xffff0000, v81
    v_add_f32 v81, 0x3727c5ac, v81
    v_cvt_pk_bf16_f32 v81, v81, v81
    v_and_b32 v81, 0xffff0000, v81
    v_sqrt_f32 v81, v81
    v_mov_b32 v83, s52
    v_cvt_pk_bf16_f32 v82, v80, v81
    s_mov_b32 exec_lo, 0x01010101
    s_mov_b32 exec_hi, 0x01010101
    buffer_store_dwordx2 v[82:83], v0, s[44:47], s65 offen sc1
    s_mov_b64 exec, -1
    buffer_load_dwordx4 v[48:51], v4, s[40:43], s66 offen
    s_add_u32 s66, s66, 28672
    buffer_load_dwordx4 v[52:55], v4, s[40:43], s66 offen
    s_add_u32 s66, s66, 28672
    buffer_load_dwordx4 v[56:59], v4, s[40:43], s66 offen
    s_add_u32 s66, s66, 28672
    buffer_load_dwordx4 v[60:63], v4, s[40:43], s66 offen
    s_add_u32 s66, s66, 28672
    buffer_load_dwordx4 v[64:67], v4, s[40:43], s66 offen
    s_add_u32 s66, s66, 28672
    buffer_load_dwordx4 v[68:71], v4, s[40:43], s66 offen
    s_add_u32 s66, s66, 28672
    buffer_load_dwordx4 v[72:75], v4, s[40:43], s66 offen
    v_and_b32 v84, 0xffff0000, v82
    v_rcp_f32 v84, v84
    v_lshlrev_b32 v86, 16, v82
    v_mov_b32 v85, v84
    v_mul_f32 v86, -v86, v84
    v_mov_b32 v87, v86
    v_lshlrev_b32 v96, 16, v16
    v_and_b32 v97, 0xffff0000, v16
    v_lshlrev_b32 v98, 16, v17
    v_and_b32 v99, 0xffff0000, v17
    v_lshlrev_b32 v100, 16, v18
    v_and_b32 v101, 0xffff0000, v18
    v_lshlrev_b32_e64 v102, 16, v19
    v_and_b32 v103, 0xffff0000, v19
    v_pk_fma_f32 v[96:97], v[96:97], v[84:85], v[86:87]
    v_pk_fma_f32 v[98:99], v[98:99], v[84:85], v[86:87]
    v_pk_fma_f32 v[100:101], v[100:101], v[84:85], v[86:87]
    v_pk_fma_f32 v[102:103], v[102:103], v[84:85], v[86:87]
    v_cvt_pk_bf16_f32 v16, v96, v97
    v_cvt_pk_bf16_f32 v17, v98, v99
    v_cvt_pk_bf16_f32 v18, v100, v101
    v_cvt_pk_bf16_f32 v19, v102, v103
    ds_write_b128 v1, v[16:19] offset:0
    v_lshlrev_b32 v104, 16, v20
    v_and_b32 v105, 0xffff0000, v20
    v_lshlrev_b32 v106, 16, v21
    v_and_b32 v107, 0xffff0000, v21
    v_lshlrev_b32 v108, 16, v22
    v_and_b32 v109, 0xffff0000, v22
    v_lshlrev_b32 v110, 16, v23
    v_and_b32 v111, 0xffff0000, v23
    v_pk_fma_f32 v[104:105], v[104:105], v[84:85], v[86:87]
    v_pk_fma_f32 v[106:107], v[106:107], v[84:85], v[86:87]
    v_pk_fma_f32 v[108:109], v[108:109], v[84:85], v[86:87]
    v_pk_fma_f32 v[110:111], v[110:111], v[84:85], v[86:87]
    v_cvt_pk_bf16_f32 v20, v104, v105
    v_cvt_pk_bf16_f32 v21, v106, v107
    v_cvt_pk_bf16_f32 v22, v108, v109
    v_cvt_pk_bf16_f32 v23, v110, v111
    ds_write_b128 v1, v[20:23] offset:128
    v_lshlrev_b32 v96, 16, v24
    v_and_b32 v97, 0xffff0000, v24
    v_lshlrev_b32 v98, 16, v25
    v_and_b32 v99, 0xffff0000, v25
    v_lshlrev_b32 v100, 16, v26
    v_and_b32 v101, 0xffff0000, v26
    v_lshlrev_b32 v102, 16, v27
    v_and_b32 v103, 0xffff0000, v27
    v_pk_fma_f32 v[96:97], v[96:97], v[84:85], v[86:87]
    v_pk_fma_f32 v[98:99], v[98:99], v[84:85], v[86:87]
    v_pk_fma_f32 v[100:101], v[100:101], v[84:85], v[86:87]
    v_pk_fma_f32 v[102:103], v[102:103], v[84:85], v[86:87]
    v_cvt_pk_bf16_f32 v24, v96, v97
    v_cvt_pk_bf16_f32 v25, v98, v99
    v_cvt_pk_bf16_f32 v26, v100, v101
    v_cvt_pk_bf16_f32 v27, v102, v103
    ds_write_b128 v1, v[24:27] offset:256
    v_lshlrev_b32 v104, 16, v28
    v_and_b32 v105, 0xffff0000, v28
    v_lshlrev_b32 v106, 16, v29
    v_and_b32 v107, 0xffff0000, v29
    v_lshlrev_b32 v108, 16, v30
    v_and_b32 v109, 0xffff0000, v30
    v_lshlrev_b32 v110, 16, v31
    v_and_b32 v111, 0xffff0000, v31
    v_pk_fma_f32 v[104:105], v[104:105], v[84:85], v[86:87]
    v_pk_fma_f32 v[106:107], v[106:107], v[84:85], v[86:87]
    v_pk_fma_f32 v[108:109], v[108:109], v[84:85], v[86:87]
    v_pk_fma_f32 v[110:111], v[110:111], v[84:85], v[86:87]
    v_cvt_pk_bf16_f32 v28, v104, v105
    v_cvt_pk_bf16_f32 v29, v106, v107
    v_cvt_pk_bf16_f32 v30, v108, v109
    v_cvt_pk_bf16_f32 v31, v110, v111
    ds_write_b128 v1, v[28:31] offset:384
    v_lshlrev_b32 v96, 16, v32
    v_and_b32 v97, 0xffff0000, v32
    v_lshlrev_b32 v98, 16, v33
    v_and_b32 v99, 0xffff0000, v33
    v_lshlrev_b32 v100, 16, v34
    v_and_b32 v101, 0xffff0000, v34
    v_lshlrev_b32 v102, 16, v35
    v_and_b32 v103, 0xffff0000, v35
    v_pk_fma_f32 v[96:97], v[96:97], v[84:85], v[86:87]
    v_pk_fma_f32 v[98:99], v[98:99], v[84:85], v[86:87]
    v_pk_fma_f32 v[100:101], v[100:101], v[84:85], v[86:87]
    v_pk_fma_f32 v[102:103], v[102:103], v[84:85], v[86:87]
    v_cvt_pk_bf16_f32 v32, v96, v97
    v_cvt_pk_bf16_f32 v33, v98, v99
    v_cvt_pk_bf16_f32 v34, v100, v101
    v_cvt_pk_bf16_f32 v35, v102, v103
    ds_write_b128 v1, v[32:35] offset:512
    v_lshlrev_b32 v104, 16, v36
    v_and_b32 v105, 0xffff0000, v36
    v_lshlrev_b32 v106, 16, v37
    v_and_b32 v107, 0xffff0000, v37
    v_lshlrev_b32 v108, 16, v38
    v_and_b32 v109, 0xffff0000, v38
    v_lshlrev_b32 v110, 16, v39
    v_and_b32 v111, 0xffff0000, v39
    v_pk_fma_f32 v[104:105], v[104:105], v[84:85], v[86:87]
    v_pk_fma_f32 v[106:107], v[106:107], v[84:85], v[86:87]
    v_pk_fma_f32 v[108:109], v[108:109], v[84:85], v[86:87]
    v_pk_fma_f32 v[110:111], v[110:111], v[84:85], v[86:87]
    v_cvt_pk_bf16_f32 v36, v104, v105
    v_cvt_pk_bf16_f32 v37, v106, v107
    v_cvt_pk_bf16_f32 v38, v108, v109
    v_cvt_pk_bf16_f32 v39, v110, v111
    ds_write_b128 v1, v[36:39] offset:640
    v_lshlrev_b32 v96, 16, v40
    v_and_b32 v97, 0xffff0000, v40
    v_lshlrev_b32 v98, 16, v41
    v_and_b32 v99, 0xffff0000, v41
    v_lshlrev_b32 v100, 16, v42
    v_and_b32 v101, 0xffff0000, v42
    v_lshlrev_b32 v102, 16, v43
    v_and_b32 v103, 0xffff0000, v43
    v_pk_fma_f32 v[96:97], v[96:97], v[84:85], v[86:87]
    v_pk_fma_f32 v[98:99], v[98:99], v[84:85], v[86:87]
    v_pk_fma_f32 v[100:101], v[100:101], v[84:85], v[86:87]
    v_pk_fma_f32 v[102:103], v[102:103], v[84:85], v[86:87]
    v_cvt_pk_bf16_f32 v40, v96, v97
    v_cvt_pk_bf16_f32 v41, v98, v99
    v_cvt_pk_bf16_f32 v42, v100, v101
    v_cvt_pk_bf16_f32 v43, v102, v103
    ds_write_b128 v1, v[40:43] offset:768
    s_waitcnt vmcnt(6)
    s_nop 0
    v_dot2_f32_bf16 v88, v48, s68, v88
    v_dot2_f32_bf16 v89, v48, s69, v89
    v_dot2_f32_bf16 v90, v49, s68, v90
    v_dot2_f32_bf16 v91, v49, s69, v91
    v_dot2_f32_bf16 v92, v50, s68, v92
    v_dot2_f32_bf16 v93, v50, s69, v93
    v_dot2_f32_bf16 v94, v51, s68, v94
    v_dot2_f32_bf16 v95, v51, s69, v95
    s_waitcnt vmcnt(5)
    s_nop 0
    v_dot2_f32_bf16 v88, v52, s68, v88
    v_dot2_f32_bf16 v89, v52, s69, v89
    v_dot2_f32_bf16 v90, v53, s68, v90
    v_dot2_f32_bf16 v91, v53, s69, v91
    v_dot2_f32_bf16 v92, v54, s68, v92
    v_dot2_f32_bf16 v93, v54, s69, v93
    v_dot2_f32_bf16 v94, v55, s68, v94
    v_dot2_f32_bf16 v95, v55, s69, v95
    s_waitcnt vmcnt(4)
    s_nop 0
    v_dot2_f32_bf16 v88, v56, s68, v88
    v_dot2_f32_bf16 v89, v56, s69, v89
    v_dot2_f32_bf16 v90, v57, s68, v90
    v_dot2_f32_bf16 v91, v57, s69, v91
    v_dot2_f32_bf16 v92, v58, s68, v92
    v_dot2_f32_bf16 v93, v58, s69, v93
    v_dot2_f32_bf16 v94, v59, s68, v94
    v_dot2_f32_bf16 v95, v59, s69, v95
    s_waitcnt vmcnt(3)
    s_nop 0
    v_dot2_f32_bf16 v88, v60, s68, v88
    v_dot2_f32_bf16 v89, v60, s69, v89
    v_dot2_f32_bf16 v90, v61, s68, v90
    v_dot2_f32_bf16 v91, v61, s69, v91
    v_dot2_f32_bf16 v92, v62, s68, v92
    v_dot2_f32_bf16 v93, v62, s69, v93
    v_dot2_f32_bf16 v94, v63, s68, v94
    v_dot2_f32_bf16 v95, v63, s69, v95
    s_waitcnt vmcnt(2)
    s_nop 0
    v_dot2_f32_bf16 v88, v64, s68, v88
    v_dot2_f32_bf16 v89, v64, s69, v89
    v_dot2_f32_bf16 v90, v65, s68, v90
    v_dot2_f32_bf16 v91, v65, s69, v91
    v_dot2_f32_bf16 v92, v66, s68, v92
    v_dot2_f32_bf16 v93, v66, s69, v93
    v_dot2_f32_bf16 v94, v67, s68, v94
    v_dot2_f32_bf16 v95, v67, s69, v95
    s_waitcnt vmcnt(1)
    s_nop 0
    v_dot2_f32_bf16 v88, v68, s68, v88
    v_dot2_f32_bf16 v89, v68, s69, v89
    v_dot2_f32_bf16 v90, v69, s68, v90
    v_dot2_f32_bf16 v91, v69, s69, v91
    v_dot2_f32_bf16 v92, v70, s68, v92
    v_dot2_f32_bf16 v93, v70, s69, v93
    v_dot2_f32_bf16 v94, v71, s68, v94
    v_dot2_f32_bf16 v95, v71, s69, v95
    s_waitcnt vmcnt(0)
    s_nop 0
    v_dot2_f32_bf16 v88, v72, s68, v88
    v_dot2_f32_bf16 v89, v72, s69, v89
    v_dot2_f32_bf16 v90, v73, s68, v90
    v_dot2_f32_bf16 v91, v73, s69, v91
    v_dot2_f32_bf16 v92, v74, s68, v92
    v_dot2_f32_bf16 v93, v74, s69, v93
    v_dot2_f32_bf16 v94, v75, s68, v94
    v_dot2_f32_bf16 v95, v75, s69, v95
    v_add_f32_dpp v88, v88, v88 row_ror:8 row_mask:0xf bank_mask:0xf
    v_add_f32_dpp v89, v89, v89 row_ror:8 row_mask:0xf bank_mask:0xf
    v_add_f32_dpp v90, v90, v90 row_ror:8 row_mask:0xf bank_mask:0xf
    v_add_f32_dpp v91, v91, v91 row_ror:8 row_mask:0xf bank_mask:0xf
    v_add_f32_dpp v92, v92, v92 row_ror:8 row_mask:0xf bank_mask:0xf
    v_add_f32_dpp v93, v93, v93 row_ror:8 row_mask:0xf bank_mask:0xf
    v_add_f32_dpp v94, v94, v94 row_ror:8 row_mask:0xf bank_mask:0xf
    v_add_f32_dpp v95, v95, v95 row_ror:8 row_mask:0xf bank_mask:0xf
    v_and_b32 v4, 8, v0
    v_cmp_eq_u32 vcc, 0, v4
    v_lshlrev_b32 v4, 1, v4
    v_lshl_add_u32 v4, v2, 5, v4
    v_lshrrev_b32 v5, 4, v0
    v_lshl_add_u32 v4, v5, 8, v4
    s_lshl_b32 s62, s54, 10
    v_add_u32 v4, s62, v4
    v_cndmask_b32 v88, v92, v88, vcc
    v_cndmask_b32 v89, v93, v89, vcc
    v_cndmask_b32 v90, v94, v90, vcc
    v_cndmask_b32 v91, v95, v91, vcc
    ds_write_b128 v4, v[88:91]
    s_lshl_b32 s62, s54, 7
    s_add_u32 s62, s62, 8192
    v_mul_u32_u24 v1, 7232, v2
    v_lshl_add_u32 v1, v3, 4, v1
    v_add_u32 v1, s62, v1
    v_mul_u32_u24 v3, 36864, v3
    v_lshl_add_u32 v3, v2, 4, v3
    v_lshlrev_b32_e64 v5, 7, v0
    s_mul_i32 s65, s54, 2304
    s_add_u32 s65, s65, s64
    s_lshl_b32 s65, s65, 7
    s_add_u32 s65, s65, 262144
    s_lshr_b32 s62, s64, 3
    s_lshl2_add_u32 s66, s54, s62
    s_lshl_b32 s66, s66, 7
    s_and_b32 s62, s64, 7
    s_add_u32 s66, s66, s62
    s_lshl2_add_u32 s66, s66, 4096
    s_mov_b32 s68, 0x05040100
    s_mov_b32 s69, 0x07060302
    s_waitcnt lgkmcnt(0)
    s_barrier
    s_cmp_eq_u32 s54, 7
    s_cbranch_scc1 L_h7
    ds_read_b128 v[16:19], v1 offset:0
    ds_read_b128 v[20:23], v1 offset:896
    ds_read_b128 v[24:27], v1 offset:1792
    ds_read_b128 v[28:31], v1 offset:2688
    ds_read_b128 v[32:35], v1 offset:3584
    ds_read_b128 v[36:39], v1 offset:4480
    ds_read_b128 v[40:43], v1 offset:5376
    ds_read_b128 v[44:47], v1 offset:6272
    s_waitcnt lgkmcnt(6)
    v_perm_b32 v48, v20, v16, s68
    s_waitcnt lgkmcnt(4)
    v_perm_b32 v49, v28, v24, s68
    s_waitcnt lgkmcnt(2)
    v_perm_b32 v50, v36, v32, s68
    s_waitcnt lgkmcnt(0)
    s_nop 0
    v_perm_b32 v51, v44, v40, s68
    buffer_store_dwordx4 v[48:51], v3, s[44:47], s65 offen sc1
    s_add_u32 s65, s65, 4608
    v_perm_b32 v52, v20, v16, s69
    v_perm_b32 v53, v28, v24, s69
    v_perm_b32 v54, v36, v32, s69
    v_perm_b32 v55, v44, v40, s69
    buffer_store_dwordx4 v[52:55], v3, s[44:47], s65 offen sc1
    s_add_u32 s65, s65, 4608
    v_perm_b32 v56, v21, v17, s68
    v_perm_b32 v57, v29, v25, s68
    v_perm_b32 v58, v37, v33, s68
    v_perm_b32 v59, v45, v41, s68
    buffer_store_dwordx4 v[56:59], v3, s[44:47], s65 offen sc1
    s_add_u32 s65, s65, 4608
    v_perm_b32 v60, v21, v17, s69
    v_perm_b32 v61, v29, v25, s69
    v_perm_b32 v62, v37, v33, s69
    v_perm_b32 v63, v45, v41, s69
    buffer_store_dwordx4 v[60:63], v3, s[44:47], s65 offen sc1
    s_add_u32 s65, s65, 4608
    v_perm_b32 v64, v22, v18, s68
    v_perm_b32 v65, v30, v26, s68
    v_perm_b32 v66, v38, v34, s68
    v_perm_b32 v67, v46, v42, s68
    buffer_store_dwordx4 v[64:67], v3, s[44:47], s65 offen sc1
    s_add_u32 s65, s65, 4608
    v_perm_b32 v68, v22, v18, s69
    v_perm_b32 v69, v30, v26, s69
    v_perm_b32 v70, v38, v34, s69
    v_perm_b32 v71, v46, v42, s69
    buffer_store_dwordx4 v[68:71], v3, s[44:47], s65 offen sc1
    s_add_u32 s65, s65, 4608
    v_perm_b32 v72, v23, v19, s68
    v_perm_b32 v73, v31, v27, s68
    v_perm_b32 v74, v39, v35, s68
    v_perm_b32 v75, v47, v43, s68
    buffer_store_dwordx4 v[72:75], v3, s[44:47], s65 offen sc1
    s_add_u32 s65, s65, 4608
    v_perm_b32 v76, v23, v19, s69
    v_perm_b32 v77, v31, v27, s69
    v_perm_b32 v78, v39, v35, s69
    v_perm_b32 v79, v47, v43, s69
    buffer_store_dwordx4 v[76:79], v3, s[44:47], s65 offen sc1
    s_waitcnt vmcnt(0)
    s_atomic_swap s52, s[44:45], s66
    s_add_u32 s66, s66, 128
    s_atomic_swap s52, s[44:45], s66
    s_add_u32 s66, s66, 128
    s_atomic_swap s52, s[44:45], s66
    s_add_u32 s66, s66, 128
    s_atomic_swap s52, s[44:45], s66
    s_branch L_hdone
L_h7:
    s_setprio 3
    s_cmp_ge_u32 s70, 14
    s_cbranch_scc1 L_hdone
    v_lshlrev_b32 v4, 2, v0
    ds_read2st64_b32 v[16:17], v4 offset0:0 offset1:1
    ds_read2st64_b32 v[18:19], v4 offset0:2 offset1:3
    ds_read2st64_b32 v[20:21], v4 offset0:4 offset1:5
    ds_read2st64_b32 v[22:23], v4 offset0:6 offset1:7
    ds_read2st64_b32 v[24:25], v4 offset0:8 offset1:9
    ds_read2st64_b32 v[26:27], v4 offset0:10 offset1:11
    ds_read2st64_b32 v[28:29], v4 offset0:12 offset1:13
    ds_read2st64_b32 v[30:31], v4 offset0:14 offset1:15
    ds_read2st64_b32 v[32:33], v4 offset0:16 offset1:17
    ds_read2st64_b32 v[34:35], v4 offset0:18 offset1:19
    ds_read2st64_b32 v[36:37], v4 offset0:20 offset1:21
    ds_read2st64_b32 v[38:39], v4 offset0:22 offset1:23
    ds_read2st64_b32 v[40:41], v4 offset0:24 offset1:25
    ds_read2st64_b32 v[42:43], v4 offset0:26 offset1:27
    ds_read2st64_b32 v[44:45], v4 offset0:28 offset1:29
    ds_read2st64_b32 v[46:47], v4 offset0:30 offset1:31
    s_waitcnt lgkmcnt(7)
    v_pk_add_f32 v[16:17], v[16:17], v[32:33]
    s_waitcnt lgkmcnt(6)
    v_pk_add_f32 v[18:19], v[18:19], v[34:35]
    s_waitcnt lgkmcnt(5)
    v_pk_add_f32 v[20:21], v[20:21], v[36:37]
    s_waitcnt lgkmcnt(4)
    v_pk_add_f32 v[22:23], v[22:23], v[38:39]
    s_waitcnt lgkmcnt(3)
    v_pk_add_f32 v[24:25], v[24:25], v[40:41]
    s_waitcnt lgkmcnt(2)
    v_pk_add_f32 v[26:27], v[26:27], v[42:43]
    s_waitcnt lgkmcnt(1)
    v_pk_add_f32 v[28:29], v[28:29], v[44:45]
    s_waitcnt lgkmcnt(0)
    v_pk_add_f32 v[30:31], v[30:31], v[46:47]
    v_pk_add_f32 v[16:17], v[16:17], v[24:25]
    v_pk_add_f32 v[18:19], v[18:19], v[26:27]
    v_pk_add_f32 v[20:21], v[20:21], v[28:29]
    v_pk_add_f32 v[22:23], v[22:23], v[30:31]
    v_pk_add_f32 v[16:17], v[16:17], v[20:21]
    v_pk_add_f32 v[18:19], v[18:19], v[22:23]
    v_pk_add_f32 v[16:17], v[16:17], v[18:19]
    v_add_f32 v82, v16, v17
    v_lshlrev_b32_e64 v4, 3, v0
    s_lshl_b32 s62, s71, 9
    s_add_u32 s62, s62, 81920
    buffer_store_dwordx2 v[82:83], v4, s[44:47], s62 offen sc1
L_hdone:
    s_setprio 0
    s_waitcnt lgkmcnt(0)
    v_min_u32 v1, 55, v0
    s_sub_u32 s72, s56, 28
    s_waitcnt vmcnt(0)
    s_cmp_lg_u32 s64, 31
    s_cbranch_scc1 L_hend
    s_cmp_lg_u32 s54, 7
    s_cbranch_scc1 L_hend
    v_lshrrev_b32 v1, 2, v0
    v_min_u32 v1, 13, v1
    v_lshlrev_b32 v1, 9, v1
    v_and_b32_e64 v2, 3, v0
    v_lshl_add_u32 v1, v2, 4, v1
    s_mov_b32 s65, 32768
    s_sleep 8
    buffer_load_dwordx4 v[16:19], v1, s[44:47], s65 offen sc1
    s_mov_b32 s96, 0
    s_waitcnt vmcnt(0)
L_chk_37:
    v_xor_b32 v3, s52, v16
    v_bitop3_b32 v3, v17, s52, v3 bitop3:0xbe
    v_bitop3_b32 v3, v18, s52, v3 bitop3:0xbe
    v_bitop3_b32 v3, v19, s52, v3 bitop3:0xbe
    v_cmp_ne_u32 vcc, 0, v3
    s_add_u32 s96, s96, 1
    s_nop 3
    s_cbranch_vccz L_chkd_38
    s_cmp_gt_u32 s96, 131072
    s_cbranch_scc1 L_chkd_38
    s_sleep 8
    buffer_load_dwordx4 v[16:19], v1, s[44:47], s65 offen sc1
    s_waitcnt vmcnt(0)
    s_branch L_chk_37
L_chkd_38:
    s_mov_b32 s65, 0
    s_mov_b64 exec, 1
    buffer_store_dword v83, off, s[44:47], s65 sc1
    s_mov_b64 exec, -1
L_hend:
    s_endpgm
L_exit:
    s_endpgm
.p2align 7
.type L_gtab,@object
L_gtab:
.long 0x8000800, 0x7fc07fc, 0x7f807fc, 0x7f807f8, 0x7f807f8, 0x7ec07ec, 0x7e807ec, 0x7e807e8
.long 0x7e807e8, 0x7dc07dc, 0x7d807dc, 0x7d807d8, 0x7d807d8, 0x7cc07cc, 0x7c807cc, 0x7c807c8
.long 0x7c807c8, 0x7bc07bc, 0x7b807bc, 0x7b807b8, 0x7b807b8, 0x7ac07ac, 0x7a807ac, 0x7a807a8
.long 0x7a807a8, 0x79c079c, 0x798079c, 0x7980798, 0x7980798, 0x78c078c, 0x788078c, 0x7880788
.long 0x7880788, 0x77c077c, 0x778077c, 0x7780778, 0x7780778, 0x76c076c, 0x768076c, 0x7680768
.long 0x7680768, 0x75c075c, 0x758075c, 0x7580758, 0x7580758, 0x74c074c, 0x748074c, 0x7480748
.long 0x7480748, 0x73c073c, 0x738073c, 0x7380738, 0x7380738, 0x72c072c, 0x728072c, 0x7280728
.long 0x7280728, 0x71c071c, 0x718071c, 0x7180718, 0x7180718, 0x70c070c, 0x708070c, 0x7080708
.long 0x7080708, 0x7f407f4, 0x7f007f4, 0x7f007f0, 0x7f007f0, 0x7e407e4, 0x7e007e4, 0x7e007e0
.long 0x7e007e0, 0x7d407d4, 0x7d007d4, 0x7d007d0, 0x7d007d0, 0x7c407c4, 0x7c007c4, 0x7c007c0
.long 0x7c007c0, 0x7b407b4, 0x7b007b4, 0x7b007b0, 0x7b007b0, 0x7a407a4, 0x7a007a4, 0x7a007a0
.long 0x7a007a0, 0x7940794, 0x7900794, 0x7900790, 0x7900790, 0x7840784, 0x7800784, 0x7800780
.long 0x7800780, 0x7740774, 0x7700774, 0x7700770, 0x7700770, 0x7640764, 0x7600764, 0x7600760
.long 0x7600760, 0x7540754, 0x7500754, 0x7500750, 0x7500750, 0x7440744, 0x7400744, 0x7400740
.long 0x7400740, 0x7340734, 0x7300734, 0x7300730, 0x7300730, 0x7240724, 0x7200724, 0x7200720
.long 0x7200720, 0x7140714, 0x7100714, 0x7100710, 0x7100710, 0x7040704, 0x7000704, 0x7000700
.long 0x7000700, 0x6fc06fc, 0x6f806fc, 0x6f806f8, 0x6f806f8, 0x6ec06ec, 0x6e806ec, 0x6e806e8
.long 0x6e806e8, 0x6dc06dc, 0x6d806dc, 0x6d806d8, 0x6d806d8, 0x6cc06cc, 0x6c806cc, 0x6c806c8
.long 0x6c806c8, 0x6bc06bc, 0x6b806bc, 0x6b806b8, 0x6b806b8, 0x6ac06ac, 0x6a806ac, 0x6a806a8
.long 0x6a806a8, 0x69c069c, 0x698069c, 0x6980698, 0x6980698, 0x68c068c, 0x688068c, 0x6880688
.long 0x6880688, 0x67c067c, 0x678067c, 0x6780678, 0x6780678, 0x66c066c, 0x668066c, 0x6680668
.long 0x6680668, 0x65c065c, 0x658065c, 0x6580658, 0x6580658, 0x64c064c, 0x648064c, 0x6480648
.long 0x6480648, 0x63c063c, 0x638063c, 0x6380638, 0x6380638, 0x62c062c, 0x628062c, 0x6280628
.long 0x6280628, 0x61c061c, 0x618061c, 0x6180618, 0x6180618, 0x60c060c, 0x608060c, 0x6080608
.long 0x6080608, 0x6f406f4, 0x6f006f4, 0x6f006f0, 0x6f006f0, 0x6e406e4, 0x6e006e4, 0x6e006e0
.long 0x6e006e0, 0x6d406d4, 0x6d006d4, 0x6d006d0, 0x6d006d0, 0x6c406c4, 0x6c006c4, 0x6c006c0
.long 0x6c006c0, 0x6b406b4, 0x6b006b4, 0x6b006b0, 0x6b006b0, 0x6a406a4, 0x6a006a4, 0x6a006a0
.long 0x6a006a0, 0x6940694, 0x6900694, 0x6900690, 0x6900690, 0x6840684, 0x6800684, 0x6800680
.long 0x6800680, 0x6740674, 0x6700674, 0x6700670, 0x6700670, 0x6640664, 0x6600664, 0x6600660
.long 0x6600660, 0x6540654, 0x6500654, 0x6500650, 0x6500650, 0x6440644, 0x6400644, 0x6400640
.long 0x6400640, 0x6340634, 0x6300634, 0x6300630, 0x6300630, 0x6240624, 0x6200624, 0x6200620
.long 0x6200620, 0x6140614, 0x6100614, 0x6100610, 0x6100610, 0x6040604, 0x6000604, 0x6000600
.long 0x7f807f8, 0xa0007ec, 0xb0009fc, 0xb000b00, 0x7e807e8, 0x9ec07dc, 0xb0009dc, 0xb000b00
.long 0x7d807d8, 0x9cc07cc, 0xb0009bc, 0xb000b00, 0x7c807c8, 0x9ac07bc, 0xb00099c, 0xb000b00
.long 0x7b807b8, 0x98c07ac, 0xb00097c, 0xb000b00, 0x7a807a8, 0x96c079c, 0xb00095c, 0xb000b00
.long 0x7980798, 0x94c078c, 0xb00093c, 0xb000b00, 0x7880788, 0x92c077c, 0xb00091c, 0xb000b00
.long 0x7780778, 0x90c076c, 0xb0009f8, 0xb000b00, 0x7680768, 0x9e8075c, 0xb0009d8, 0xb000b00
.long 0x7580758, 0x9c8074c, 0xb0009b8, 0xb000b00, 0x7480748, 0x9a8073c, 0xb000998, 0xb000b00
.long 0x7380738, 0x988072c, 0xb000978, 0xb000b00, 0x7280728, 0x968071c, 0xb000958, 0xb000b00
.long 0x7180718, 0x948070c, 0xb000938, 0xb000b00, 0x7080708, 0x92807f4, 0xb000918, 0xb000b00
.long 0x7f007f0, 0x90807e4, 0xb0009f4, 0xb000b00, 0x7e007e0, 0x9e407d4, 0xb0009d4, 0xb000b00
.long 0x7d007d0, 0x9c407c4, 0xb0009b4, 0xb000b00, 0x7c007c0, 0x9a407b4, 0xb000994, 0xb000b00
.long 0x7b007b0, 0x98407a4, 0xb000974, 0xb000b00, 0x7a007a0, 0x9640794, 0xb000954, 0xb000b00
.long 0x7900790, 0x9440784, 0xb000934, 0xb000b00, 0x7800780, 0x9240774, 0xb000914, 0xb000b00
.long 0x7700770, 0x9040764, 0xb0009f0, 0xb000b00, 0x7600760, 0x9e00754, 0xb0009d0, 0xb000b00
.long 0x7500750, 0x9c00744, 0xb0009b0, 0xb000b00, 0x7400740, 0x9a00734, 0xb000990, 0xb000b00
.long 0x7300730, 0x9800724, 0xb000970, 0xb000b00, 0x7200720, 0x9600714, 0xb000950, 0xb000b00
.long 0x7100710, 0x9400704, 0xb000930, 0xb000b00, 0x7000700, 0x92006fc, 0xb000910, 0xb000b00
.long 0x6f806f8, 0x90006ec, 0xb0008fc, 0xb000b00, 0x6e806e8, 0x8ec06dc, 0xb0008dc, 0xb000b00
.long 0x6d806d8, 0x8cc06cc, 0xb0008bc, 0xb000b00, 0x6c806c8, 0x8ac06bc, 0xb00089c, 0xb000b00
.long 0x6b806b8, 0x88c06ac, 0xb00087c, 0xb000b00, 0x6a806a8, 0x86c069c, 0xb00085c, 0xb000b00
.long 0x6980698, 0x84c068c, 0xb00083c, 0xb000b00, 0x6880688, 0x82c067c, 0xb00081c, 0xb000b00
.long 0x6780678, 0x80c066c, 0xb0008f8, 0xb000b00, 0x6680668, 0x8e8065c, 0xb0008d8, 0xb000b00
.long 0x6580658, 0x8c8064c, 0xb0008b8, 0xb000b00, 0x6480648, 0x8a8063c, 0xb000898, 0xb000b00
.long 0x6380638, 0x888062c, 0xb000878, 0xb000b00, 0x6280628, 0x868061c, 0xb000858, 0xb000b00
.long 0x6180618, 0x848060c, 0xb000838, 0xb000b00, 0x6080608, 0x82806f4, 0xb000818, 0xb000b00
.long 0x6f006f0, 0x80806e4, 0xb0008f4, 0xb000b00, 0x6e006e0, 0x8e406d4, 0xb0008d4, 0xb000b00
.long 0x6d006d0, 0x8c406c4, 0xb0008b4, 0xb000b00, 0x6c006c0, 0x8a406b4, 0xb000894, 0xb000b00
.long 0x6b006b0, 0x88406a4, 0xb000874, 0xb000b00, 0x6a006a0, 0x8640694, 0xb000854, 0xb000b00
.long 0x6900690, 0x8440684, 0xb000834, 0xb000b00, 0x6800680, 0x8240674, 0xb000814, 0xb000b00
.long 0x6700670, 0x8040664, 0xb0008f0, 0xb000b00, 0x6600660, 0x8e00654, 0xb0008d0, 0xb000b00
.long 0x6500650, 0x8c00644, 0xb0008b0, 0xb000b00, 0x6400640, 0x8a00634, 0xb000890, 0xb000b00
.long 0x6300630, 0x8800624, 0xb000870, 0xb000b00, 0x6200620, 0x8600614, 0xb000850, 0xb000b00
.long 0x6100610, 0x8400604, 0xb000830, 0xb000b00, 0x5fc0600, 0x82005f8, 0xb000810, 0xb000b00
.long 0x5fc0600, 0x5f805f8, 0x5f405f8, 0x5f005f0, 0x5ec05f0, 0x5e805e8, 0x5e405e8, 0x5e005e0
.long 0x5dc05e0, 0x5d805d8, 0x5d405d8, 0x5d005d0, 0x5cc05d0, 0x5c805c8, 0x5c405c8, 0x5c005c0
.long 0x5bc05c0, 0x5b805b8, 0x5b405b8, 0x5b005b0, 0x5ac05b0, 0x5a805a8, 0x5a405a8, 0x5a005a0
.long 0x59c05a0, 0x5980598, 0x5940598, 0x5900590, 0x58c0590, 0x5880588, 0x5840588, 0x5800580
.long 0x57c0580, 0x5780578, 0x5740578, 0x5700570, 0x56c0570, 0x5680568, 0x5640568, 0x5600560
.long 0x55c0560, 0x5580558, 0x5540558, 0x5500550, 0x54c0550, 0x5480548, 0x5440548, 0x5400540
.long 0x53c0540, 0x5380538, 0x5340538, 0x5300530, 0x52c0530, 0x5280528, 0x5240528, 0x5200520
.long 0x51c0520, 0x5180518, 0x5140518, 0x5100510, 0x50c0510, 0x5080508, 0x5040508, 0x5000500
.long 0x4fc0500, 0x4f804f8, 0x4f404f8, 0x4f004f0, 0x4ec04f0, 0x4e804e8, 0x4e404e8, 0x4e004e0
.long 0x4dc04e0, 0x4d804d8, 0x4d404d8, 0x4d004d0, 0x4cc04d0, 0x4c804c8, 0x4c404c8, 0x4c004c0
.long 0x4bc04c0, 0x4b804b8, 0x4b404b8, 0x4b004b0, 0x4ac04b0, 0x4a804a8, 0x4a404a8, 0x4a004a0
.long 0x49c04a0, 0x4980498, 0x4940498, 0x4900490, 0x48c0490, 0x4880488, 0x4840488, 0x4800480
.long 0x47c0480, 0x4780478, 0x4740478, 0x4700470, 0x46c0470, 0x4680468, 0x4640468, 0x4600460
.long 0x45c0460, 0x4580458, 0x4540458, 0x4500450, 0x44c0450, 0x4480448, 0x4440448, 0x4400440
.long 0x43c0440, 0x4380438, 0x4340438, 0x4300430, 0x42c0430, 0x4280428, 0x4240428, 0x4200420
.long 0x41c0420, 0x4180418, 0x4140418, 0x4100410, 0x40c0410, 0x4080408, 0x4040408, 0x4000400
.long 0x3f803fc, 0x3f003f4, 0x2f802fc, 0x2f002f4, 0x3e803ec, 0x3e003e4, 0x2e802ec, 0x2e002e4
.long 0x3d803dc, 0x3d003d4, 0x2d802dc, 0x2d002d4, 0x3c803cc, 0x3c003c4, 0x2c802cc, 0x2c002c4
.long 0x3b803bc, 0x3b003b4, 0x2b802bc, 0x2b002b4, 0x3a803ac, 0x3a003a4, 0x2a802ac, 0x2a002a4
.long 0x398039c, 0x3900394, 0x298029c, 0x2900294, 0x388038c, 0x3800384, 0x288028c, 0x2800284
.long 0x378037c, 0x3700374, 0x278027c, 0x2700274, 0x368036c, 0x3600364, 0x268026c, 0x2600264
.long 0x358035c, 0x3500354, 0x258025c, 0x2500254, 0x348034c, 0x3400344, 0x248024c, 0x2400244
.long 0x338033c, 0x3300334, 0x238023c, 0x2300234, 0x328032c, 0x3200324, 0x228022c, 0x2200224
.long 0x318031c, 0x3100314, 0x218021c, 0x2100214, 0x308030c, 0x3000304, 0x208020c, 0x2000204
.long 0x1f801fc, 0x1f001f4, 0xf800fc, 0xf000f4, 0x1e801ec, 0x1e001e4, 0xe800ec, 0xe000e4
.long 0x1d801dc, 0x1d001d4, 0xd800dc, 0xd000d4, 0x1c801cc, 0x1c001c4, 0xc800cc, 0xc000c4
.long 0x1b801bc, 0x1b001b4, 0xb800bc, 0xb000b4, 0x1a801ac, 0x1a001a4, 0xa800ac, 0xa000a4
.long 0x198019c, 0x1900194, 0x98009c, 0x900094, 0x188018c, 0x1800184, 0x88008c, 0x800084
.long 0x178017c, 0x1700174, 0x78007c, 0x700074, 0x168016c, 0x1600164, 0x68006c, 0x600064
.long 0x158015c, 0x1500154, 0x58005c, 0x500054, 0x148014c, 0x1400144, 0x48004c, 0x400044
.long 0x138013c, 0x1300134, 0x38003c, 0x300034, 0x128012c, 0x1200124, 0x28002c, 0x200024
.long 0x118011c, 0x1100114, 0x18001c, 0x100014, 0x108010c, 0x1000104, 0x8000c, 0x4
.long 0x5ec05f0, 0xb0005e8, 0xb000b00, 0xb000b00, 0x5dc05e0, 0xb0005d8, 0xb000b00, 0xb000b00
.long 0x5cc05d0, 0xb0005c8, 0xb000b00, 0xb000b00, 0x5bc05c0, 0xb0005b8, 0xb000b00, 0xb000b00
.long 0x5ac05b0, 0xb0005a8, 0xb000b00, 0xb000b00, 0x59c05a0, 0xb000598, 0xb000b00, 0xb000b00
.long 0x58c0590, 0xb000588, 0xb000b00, 0xb000b00, 0x57c0580, 0xb000578, 0xb000b00, 0xb000b00
.long 0x56c0570, 0xb000568, 0xb000b00, 0xb000b00, 0x55c0560, 0xb000558, 0xb000b00, 0xb000b00
.long 0x54c0550, 0xb000548, 0xb000b00, 0xb000b00, 0x53c0540, 0xb000538, 0xb000b00, 0xb000b00
.long 0x52c0530, 0xb000528, 0xb000b00, 0x8000800, 0x51c0520, 0xb000518, 0x8000b00, 0x8000800
.long 0x50c0510, 0xb000508, 0x8000800, 0x8000800, 0x4fc0500, 0x80004f8, 0x8000800, 0x7fc0800
.long 0x4ec04f0, 0xb0004e8, 0xb000b00, 0xb000b00, 0x4dc04e0, 0xb0004d8, 0xb000b00, 0xb000b00
.long 0x4cc04d0, 0xb0004c8, 0xb000b00, 0xb000b00, 0x4bc04c0, 0xb0004b8, 0xb000b00, 0xb000b00
.long 0x4ac04b0, 0xb0004a8, 0xb000b00, 0xb000b00, 0x49c04a0, 0xb000498, 0xb000b00, 0xb000b00
.long 0x48c0490, 0xb000488, 0xb000b00, 0xb000b00, 0x47c0480, 0xb000478, 0xb000b00, 0xb000b00
.long 0x46c0470, 0xb000468, 0xb000b00, 0xb000b00, 0x45c0460, 0xb000458, 0xb000b00, 0xb000b00
.long 0x44c0450, 0xb000448, 0xb000b00, 0xb000b00, 0x43c0440, 0xb000438, 0xb000b00, 0xb000b00
.long 0x42c0430, 0xb000428, 0xb000b00, 0xb000b00, 0x41c0420, 0xb000418, 0xb000b00, 0xb000b00
.long 0x40c0410, 0xb000408, 0xb000b00, 0xb000b00, 0x3f803fc, 0xb0003f4, 0xb000b00, 0xb000b00
.long 0x3e803ec, 0xb0003e4, 0xb000b00, 0xb000b00, 0x3d803dc, 0xb0003d4, 0xb000b00, 0xb000b00
.long 0x3c803cc, 0xb0003c4, 0xb000b00, 0xb000b00, 0x3b803bc, 0xb0003b4, 0xb000b00, 0xb000b00
.long 0x3a803ac, 0xb0003a4, 0xb000b00, 0xb000b00, 0x398039c, 0xb000394, 0xb000b00, 0xb000b00
.long 0x388038c, 0xb000384, 0xb000b00, 0xb000b00, 0x378037c, 0xb000374, 0xb000b00, 0xb000b00
.long 0x368036c, 0xb000364, 0xb000b00, 0xb000b00, 0x358035c, 0xb000354, 0xb000b00, 0xb000b00
.long 0x348034c, 0xb000344, 0xb000b00, 0xb000b00, 0x338033c, 0xb000334, 0xb000b00, 0xb000b00
.long 0x328032c, 0xb000324, 0xb000b00, 0xb000b00, 0x318031c, 0xb000314, 0xb000b00, 0xb000b00
.long 0x308030c, 0xb000304, 0xb000b00, 0xb000b00, 0x1f801fc, 0xb0001f4, 0xb000b00, 0xb000b00
.long 0x1e801ec, 0xb0001e4, 0xb000b00, 0xb000b00, 0x1d801dc, 0xb0001d4, 0xb000b00, 0xb000b00
.long 0x1c801cc, 0xb0001c4, 0xb000b00, 0xb000b00, 0x1b801bc, 0xb0001b4, 0xb000b00, 0xb000b00
.long 0x1a801ac, 0xb0001a4, 0xb000b00, 0xb000b00, 0x198019c, 0xb000194, 0xb000b00, 0xb000b00
.long 0x188018c, 0xb000184, 0xb000b00, 0xb000b00, 0x178017c, 0xb000174, 0xb000b00, 0xb000b00
.long 0x168016c, 0xb000164, 0xb000b00, 0xb000b00, 0x158015c, 0xb000154, 0xb000b00, 0xb000b00
.long 0x148014c, 0xb000144, 0xb000b00, 0xb000b00, 0x138013c, 0xb000134, 0xb000b00, 0xb000b00
.long 0x128012c, 0xb000124, 0xb000b00, 0xb000b00, 0x118011c, 0xb000114, 0xb000b00, 0xb000b00
.long 0x108010c, 0xb000104, 0xb000b00, 0xb000b00, 0xb000b00, 0xb000b00, 0xb000b00, 0xb000b00
L_end:
.section .rodata,"a"
.p2align 6
.amdhsa_kernel recurrent_scan__ssm_conv_s4__dense_activation_mish__prompt_kernel
  .amdhsa_next_free_vgpr 256
  .amdhsa_next_free_sgpr 102
  .amdhsa_accum_offset 256
  .amdhsa_group_segment_fixed_size 0
  .amdhsa_kernarg_size 128
  .amdhsa_user_sgpr_count 2
  .amdhsa_user_sgpr_kernarg_segment_ptr 1
  .amdhsa_system_sgpr_workgroup_id_x 1
.end_amdhsa_kernel
```
